```python
import torch

def _softmax(x, axis=-1):
    return torch.softmax(x, dim=axis)
def _gelu(x):
    return torch.nn.functional.gelu(x, approximate="tanh")
def _silu(x):
    return torch.nn.functional.silu(x)
def _sigmoid(x):
    return torch.sigmoid(x)
def _layernorm(x, axis=-1, eps=1e-5):
    m = x.mean(dim=axis, keepdim=True)
    v = x.var(dim=axis, keepdim=True, unbiased=False)
    return (x - m) / torch.sqrt(v + eps)
def _scatter_add(tgt, idx, src, axis=0):
    return tgt.clone().index_add_(axis, idx, src)
def _segment_sum(src, seg, n):
    out = torch.zeros((n,) + src.shape[1:], dtype=src.dtype)
    return out.index_add_(0, seg, src)
def _pad(x, pw):
    flat = tuple(v for pair in reversed(pw) for v in pair)
    return torch.nn.functional.pad(x, flat)

kernel_name = 'recurrent_scan__sliding_block_cached__mixer_channel_mlp__decode'

def setup_inputs():

    _w = (lambda a: (lambda t: t.to(torch.bfloat16) if t.is_floating_point() else t)(torch.as_tensor(a)))
    def _A_setup():
        B, Sq, D = 1, 1, 512
        Hq, Hkv, Sk, Dh = 32, 32, 32768, 128
        assert Hq % Hkv == 0, (Hq, Hkv)
        return {
            "x": _w((lambda *s: torch.randn(*s, dtype=torch.bfloat16) * 0.1)(B, Sq, D)),
            "k_cache": _w((lambda *s: torch.randn(*s, dtype=torch.bfloat16) * 0.8)(B, Hkv, Sk, Dh)),
            "v_cache": _w((lambda *s: torch.randn(*s, dtype=torch.bfloat16) * 3.2)(B, Hkv, Sk, Dh)),
            "wq": _w((lambda *s: torch.randn(*s, dtype=torch.bfloat16) * 0.8)(D, Hq * Dh) * (D ** -0.5)),
            "wo": _w((lambda *s: torch.randn(*s, dtype=torch.bfloat16) * 3.2)(Hq * Dh, D) * ((Hq * Dh) ** -0.5)),
        }
    _A_in = _A_setup()

    def _B_setup():
        B, S, D, F = 1, 1, 512, 1376
        return {
            "x": _w((lambda *s: torch.randn(*s, dtype=torch.bfloat16) * 0.1)(B, S, D)),
            "w1": _w((lambda *s: torch.randn(*s, dtype=torch.bfloat16) * 3.2)(D, F) * (D ** -0.5)),
            "b1": _w((lambda *s: torch.randn(*s, dtype=torch.bfloat16) * 3.2)(F)),
            "w2": _w((lambda *s: torch.randn(*s, dtype=torch.bfloat16) * 3.2)(F, D) * (F ** -0.5)),
            "b2": _w((lambda *s: torch.randn(*s, dtype=torch.bfloat16) * 3.2)(D)),
        }
    _B_in = _B_setup()

    return {
        "A_x": _A_in["x"],
        "A_k_cache": _A_in["k_cache"],
        "A_v_cache": _A_in["v_cache"],
        "A_wq": _A_in["wq"],
        "A_wo": _A_in["wo"],
        "B_x": _B_in["x"],
        "B_w1": _B_in["w1"],
        "B_b1": _B_in["b1"],
        "B_w2": _B_in["w2"],
        "B_b2": _B_in["b2"],
    }

def reference(A_x, A_k_cache, A_v_cache, A_wq, A_wo, B_x, B_w1, B_b1, B_w2, B_b2):
    def _A_ref(x, k_cache, v_cache, wq, wo):
        B, Sq, D = x.shape
        Hq, Dh = 32, 128
        Hkv, Sk = k_cache.shape[1], k_cache.shape[2]
        W = min(4096, max(256, Sk // 4))
        rep = Hq // Hkv
        q = (lambda x, *d: x.permute(*d))((x @ wq).reshape(B, Sq, Hq, Dh), 0, 2, 1, 3)
        k = (lambda x, n, axis: torch.repeat_interleave(x, n, dim=axis))(k_cache[:, :, Sk - W:, :], rep, axis=1)
        v = (lambda x, n, axis: torch.repeat_interleave(x, n, dim=axis))(v_cache[:, :, Sk - W:, :], rep, axis=1)
        scores = torch.einsum("bhqd,bhkd->bhqk", q, k) * (Dh ** -0.5)
        p = _softmax(scores, axis=-1)
        o = torch.einsum("bhqk,bhkd->bhqd", p, v)
        return (lambda x, *d: x.permute(*d))(o, 0, 2, 1, 3).reshape(B, Sq, Hq * Dh) @ wo

    def _B_ref(x, w1, b1, w2, b2):
        y = _layernorm(x, axis=-1)
        h = _gelu(torch.einsum("bsd,df->bsf", y, w1) + b1)
        return torch.einsum("bsf,fd->bsd", h, w2) + b2

    x = A_x
    xn = _layernorm(x, axis=-1)
    s = _A_ref(xn, A_k_cache, A_v_cache, A_wq, A_wo)
    g = _silu(_B_ref(xn, B_w1, B_b1, B_w2, B_b2))
    return x + s * g
```

```asm
; @launch grid=(256,1,1) block=(768,1,1) lds=26880
.amdgcn_target "amdgcn-amd-amdhsa--gfx950"
.text
.globl recurrent_scan__sliding_block_cached__mixer_channel_mlp__decode_kernel
.p2align 8
.type recurrent_scan__sliding_block_cached__mixer_channel_mlp__decode_kernel,@function
recurrent_scan__sliding_block_cached__mixer_channel_mlp__decode_kernel:
    s_load_dwordx16 s[16:31], s[0:1], 0
    v_lshrrev_b32 v2, 6, v0
    s_cmpk_ge_u32 s2, 256
    s_cbranch_scc1 L_end
    v_readfirstlane_b32 s5, v2
    s_load_dwordx8 s[32:39], s[0:1], 64
    s_load_dwordx2 s[40:41], s[0:1], 96
    s_and_b32 s8, s5, 14
    s_cmp_lg_u32 s8, 2
    s_cbranch_scc1 L_not23
    v_mov_b64 v[8:9], 0
    v_mov_b64 v[10:11], 0
    ds_write_b128 v8, v[8:11] offset:4160
    s_waitcnt lgkmcnt(0)
    s_load_dword s88, s[28:29], 0
    s_barrier
    s_branch L_h23
L_not23:
    s_and_b32 s3, s2, 7
    s_bfe_u32 s9, s2, 0x20003
    s_lshl2_add_u32 s3, s3, s9
    s_lshr_b32 s4, s2, 5
    v_and_b32 v1, 63, v0
    v_and_b32 v2, 15, v0
    v_lshrrev_b32 v3, 4, v1
    s_sub_u32 s11, s5, 4
    s_cbranch_scc1 L_01
    s_and_b32 s8, s11, 3
    s_xor_b32 s8, s8, s4
    s_lshl3_add_u32 s9, s9, s11
    s_lshl3_add_u32 s8, s9, s8
    s_lshl_b32 s9, s3, 11
    s_add_u32 s8, s8, s9
    s_addk_i32 s8, 0x700
    s_lshl_b32 s8, s8, 12
    v_and_b32 v4, 12, v0
    v_add_lshl_u32 v4, v4, v3, 2
    v_and_or_b32 v4, v0, 3, v4
    v_lshl_add_u32 v4, v4, 4, s8
    s_cmp_lg_u32 s11, 3
    s_waitcnt lgkmcnt(0)
    s_cbranch_scc1 L_net
    s_load_dword s88, s[18:19], s8
L_net:
    s_barrier
    global_load_dwordx4 v[40:43], v4, s[18:19] offset:0 nt
    global_load_dwordx4 v[44:47], v4, s[18:19] offset:1024 nt
    global_load_dwordx4 v[48:51], v4, s[18:19] offset:2048 nt
    global_load_dwordx4 v[52:55], v4, s[18:19] offset:3072 nt
    s_branch L_kv1
L_01:
    v_lshlrev_b32 v5, 4, v1
    s_cmp_eq_u32 s5, 1
    s_cbranch_scc1 L_mlp0
    v_lshlrev_b32 v6, 17, v3
    v_lshl_add_u32 v6, v2, 4, v6
    s_lshl_b32 s8, s4, 19
    s_lshl_b32 s9, s3, 8
    s_add_u32 s8, s8, s9
    s_movk_i32 s9, 0x2000
    v_add_u32 v40, s8, v6
    v_add_u32 v41, s9, v40
    v_add_u32 v42, s9, v41
    v_add_u32 v43, s9, v42
    v_add_u32 v44, s9, v43
    v_add_u32 v45, s9, v44
    v_add_u32 v46, s9, v45
    v_add_u32 v47, s9, v46
    v_add_u32 v48, s9, v47
    v_add_u32 v49, s9, v48
    v_add_u32 v50, s9, v49
    v_add_u32 v51, s9, v50
    v_add_u32 v52, s9, v51
    v_add_u32 v53, s9, v52
    v_add_u32 v54, s9, v53
    v_add_u32 v55, s9, v54
    s_waitcnt lgkmcnt(0)
    global_load_dwordx4 v[8:11], v5, s[16:17]
    global_load_dwordx4 v[104:107], v40, s[22:23] nt
    global_load_dwordx4 v[108:111], v41, s[22:23] nt
    global_load_dwordx4 v[112:115], v42, s[22:23] nt
    global_load_dwordx4 v[116:119], v43, s[22:23] nt
    global_load_dwordx4 v[120:123], v44, s[22:23] nt
    global_load_dwordx4 v[124:127], v45, s[22:23] nt
    global_load_dwordx4 v[128:131], v46, s[22:23] nt
    global_load_dwordx4 v[132:135], v47, s[22:23] nt
    global_load_dwordx4 v[136:139], v48, s[22:23] nt
    global_load_dwordx4 v[140:143], v49, s[22:23] nt
    global_load_dwordx4 v[144:147], v50, s[22:23] nt
    global_load_dwordx4 v[148:151], v51, s[22:23] nt
    global_load_dwordx4 v[152:155], v52, s[22:23] nt
    global_load_dwordx4 v[156:159], v53, s[22:23] nt
    global_load_dwordx4 v[160:163], v54, s[22:23] nt
    global_load_dwordx4 v[164:167], v55, s[22:23] nt
    s_barrier
    s_branch L_q
L_mlp0:
    s_mul_i32 s46, s3, 43
    s_add_u32 s47, s46, 43
    s_lshr_b32 s46, s46, 3
    s_lshr_b32 s47, s47, 3
    s_sub_u32 s47, s47, s46
    v_and_b32 v7, 7, v1
    v_lshrrev_b32 v6, 3, v1
    v_cmp_gt_u32 s[50:51], s47, v7
    v_add_u32 v12, s46, v7
    v_lshlrev_b32 v13, 3, v12
    v_add_lshl_u32 v61, v13, v6, 1
    s_lshl_b32 s8, s4, 6
    v_lshl_add_u32 v14, v6, 3, s8
    s_movk_i32 s9, 2752
    v_mul_lo_u32 v14, v14, s9
    s_movk_i32 s9, 5504
    v_lshl_add_u32 v100, v12, 4, v14
    v_add_u32 v101, s9, v100
    v_add_u32 v102, s9, v101
    v_add_u32 v103, s9, v102
    s_waitcnt lgkmcnt(0)
    global_load_dwordx4 v[8:11], v5, s[16:17]
    s_mov_b64 exec, s[50:51]
    global_load_dwordx4 v[64:67], v100, s[28:29] offset:0 nt
    global_load_dwordx4 v[68:71], v100, s[28:29] offset:2752 nt
    global_load_dwordx4 v[72:75], v101, s[28:29] offset:0 nt
    global_load_dwordx4 v[76:79], v101, s[28:29] offset:2752 nt
    global_load_dwordx4 v[80:83], v102, s[28:29] offset:0 nt
    global_load_dwordx4 v[84:87], v102, s[28:29] offset:2752 nt
    global_load_dwordx4 v[88:91], v103, s[28:29] offset:0 nt
    global_load_dwordx4 v[92:95], v103, s[28:29] offset:2752 nt
    s_mov_b64 exec, -1
    s_barrier
    s_branch L_mlp
L_kv1:
    v_lshlrev_b32 v5, 10, v3
    v_lshl_add_u32 v5, v2, 4, v5
    v_add_u32 v5, s8, v5
    s_lshl_b32 s10, s3, 3
    s_add_u32 s10, s10, s4
    s_mov_b32 s45, 0xffff0000
    s_mov_b32 s7, 1048576
    s_load_dword s42, s[40:41], 0
    v_and_b32 v10, 1, v2
    v_lshlrev_b32 v10, 4, v10
    v_mov_b32 v11, 0xffff
    v_lshlrev_b32 v10, v10, v11
    v_lshrrev_b32 v11, 1, v2
    v_cmp_eq_u32 vcc, 0, v11
    s_nop 1
    v_cndmask_b32 v6, 0, v10, vcc
    v_cmp_eq_u32 vcc, 1, v11
    s_nop 1
    v_cndmask_b32 v7, 0, v10, vcc
    v_cmp_eq_u32 vcc, 2, v11
    s_nop 1
    v_cndmask_b32 v8, 0, v10, vcc
    v_cmp_eq_u32 vcc, 3, v11
    s_nop 1
    v_cndmask_b32 v9, 0, v10, vcc
    s_mov_b32 s54, 0xaaaaaaaa
    s_mov_b32 s55, 0xaaaaaaaa
    s_mov_b32 s46, 0x3fb8aa3b
    v_mov_b32 v24, 0
    v_mov_b32 v25, 0
    v_mov_b32 v26, 0
    v_mov_b32 v27, 0
    v_mov_b32 v28, 0
    v_mov_b32 v29, 0
    v_mov_b32 v30, 0
    v_mov_b32 v31, 0
    v_mov_b32 v32, 0
    v_mov_b32 v33, 0
    v_mov_b32 v34, 0
    v_mov_b32 v35, 0
    v_mov_b32 v36, 0
    v_mov_b32 v37, 0
    v_mov_b32 v38, 0
    v_mov_b32 v39, 0
    v_xor_b32 v4, 262144, v4
    s_waitcnt vmcnt(0)
    global_load_dwordx4 v[56:59], v4, s[18:19] offset:0 nt
    global_load_dwordx4 v[60:63], v4, s[18:19] offset:1024 nt
    global_load_dwordx4 v[64:67], v4, s[18:19] offset:2048 nt
    global_load_dwordx4 v[68:71], v4, s[18:19] offset:3072 nt
    s_waitcnt vmcnt(0)
    global_load_dwordx4 v[72:75], v5, s[20:21] offset:0 nt
    global_load_dwordx4 v[76:79], v5, s[20:21] offset:256 nt
    global_load_dwordx4 v[80:83], v5, s[20:21] offset:512 nt
    global_load_dwordx4 v[84:87], v5, s[20:21] offset:768 nt
    v_mov_b32 v12, 1
    v_mov_b32 v13, 4168
    s_mov_b64 exec, 1
    ds_add_u32 v13, v12
    s_mov_b64 exec, -1
    v_xor_b32 v5, 262144, v5
    s_waitcnt vmcnt(0)
    global_load_dwordx4 v[88:91], v5, s[20:21] offset:0 nt
    global_load_dwordx4 v[92:95], v5, s[20:21] offset:256 nt
    global_load_dwordx4 v[96:99], v5, s[20:21] offset:512 nt
    global_load_dwordx4 v[100:103], v5, s[20:21] offset:768 nt
    v_xor_b32 v4, 786432, v4
    s_waitcnt vmcnt(0)
    global_load_dwordx4 v[104:107], v4, s[18:19] offset:0 nt
    global_load_dwordx4 v[108:111], v4, s[18:19] offset:1024 nt
    global_load_dwordx4 v[112:115], v4, s[18:19] offset:2048 nt
    global_load_dwordx4 v[116:119], v4, s[18:19] offset:3072 nt
    v_xor_b32 v4, 262144, v4
    s_waitcnt vmcnt(0)
    global_load_dwordx4 v[120:123], v4, s[18:19] offset:0 nt
    global_load_dwordx4 v[124:127], v4, s[18:19] offset:1024 nt
    global_load_dwordx4 v[128:131], v4, s[18:19] offset:2048 nt
    global_load_dwordx4 v[132:135], v4, s[18:19] offset:3072 nt
    v_mov_b32 v16, 4160
    v_and_b32 v17, 3, v2
    v_lshlrev_b32 v17, 4, v17
    v_lshl_add_u32 v17, v3, 6, v17
L_qw:
    ds_read_b32 v10, v16
    ds_read_b128 v[12:15], v17 offset:4352
    s_waitcnt lgkmcnt(0)
    v_cmp_eq_u32 vcc, 0, v10
    s_cbranch_vccz L_qw_ok
    s_sub_u32 s7, s7, 1
    s_cbranch_scc1 L_end
    s_sleep 2
    s_branch L_qw
L_qw_ok:
    v_mov_b32_dpp v24, v12 quad_perm:[0,1,2,3] row_mask:0xf bank_mask:1
    v_mov_b32_dpp v25, v13 quad_perm:[0,1,2,3] row_mask:0xf bank_mask:1
    v_mov_b32_dpp v26, v14 quad_perm:[0,1,2,3] row_mask:0xf bank_mask:1
    v_mov_b32_dpp v27, v15 quad_perm:[0,1,2,3] row_mask:0xf bank_mask:1
    v_mov_b32_dpp v28, v12 quad_perm:[0,1,2,3] row_mask:0xf bank_mask:2
    v_mov_b32_dpp v29, v13 quad_perm:[0,1,2,3] row_mask:0xf bank_mask:2
    v_mov_b32_dpp v30, v14 quad_perm:[0,1,2,3] row_mask:0xf bank_mask:2
    v_mov_b32_dpp v31, v15 quad_perm:[0,1,2,3] row_mask:0xf bank_mask:2
    v_mov_b32_dpp v32, v12 quad_perm:[0,1,2,3] row_mask:0xf bank_mask:4
    v_mov_b32_dpp v33, v13 quad_perm:[0,1,2,3] row_mask:0xf bank_mask:4
    v_mov_b32_dpp v34, v14 quad_perm:[0,1,2,3] row_mask:0xf bank_mask:4
    v_mov_b32_dpp v35, v15 quad_perm:[0,1,2,3] row_mask:0xf bank_mask:4
    v_mov_b32_dpp v36, v12 quad_perm:[0,1,2,3] row_mask:0xf bank_mask:8
    v_mov_b32_dpp v37, v13 quad_perm:[0,1,2,3] row_mask:0xf bank_mask:8
    v_mov_b32_dpp v38, v14 quad_perm:[0,1,2,3] row_mask:0xf bank_mask:8
    v_mov_b32_dpp v39, v15 quad_perm:[0,1,2,3] row_mask:0xf bank_mask:8
    v_mfma_f32_16x16x32_bf16 v[12:15], v[24:27], v[40:43], 0
    v_mfma_f32_16x16x32_bf16 v[12:15], v[28:31], v[44:47], v[12:15]
    v_mfma_f32_16x16x32_bf16 v[12:15], v[32:35], v[48:51], v[12:15]
    v_mfma_f32_16x16x32_bf16 v[12:15], v[36:39], v[52:55], v[12:15]
    v_mfma_f32_16x16x32_bf16 v[16:19], v[24:27], v[56:59], 0
    v_mfma_f32_16x16x32_bf16 v[16:19], v[28:31], v[60:63], v[16:19]
    v_mfma_f32_16x16x32_bf16 v[16:19], v[32:35], v[64:67], v[16:19]
    v_mfma_f32_16x16x32_bf16 v[16:19], v[36:39], v[68:71], v[16:19]
    s_nop 3
    v_mov_b32_dpp v0, v12 quad_perm:[0,0,0,0] row_mask:0xf bank_mask:0xf
    s_nop 2
    v_mov_b32_dpp v1, v16 quad_perm:[0,0,0,0] row_mask:0xf bank_mask:0xf
    v_add_f32_dpp v0, v13, v0 quad_perm:[1,1,1,1] row_mask:0xf bank_mask:0xf
    s_nop 0
    v_add_f32_dpp v1, v17, v1 quad_perm:[1,1,1,1] row_mask:0xf bank_mask:0xf
    v_add_f32_dpp v0, v14, v0 quad_perm:[2,2,2,2] row_mask:0xf bank_mask:0xf
    s_nop 0
    v_add_f32_dpp v1, v18, v1 quad_perm:[2,2,2,2] row_mask:0xf bank_mask:0xf
    v_add_f32_dpp v0, v15, v0 quad_perm:[3,3,3,3] row_mask:0xf bank_mask:0xf
    s_nop 0
    v_add_f32_dpp v1, v19, v1 quad_perm:[3,3,3,3] row_mask:0xf bank_mask:0xf
    v_cndmask_b32 v12, v0, v1, s[54:55]
    v_cvt_pk_bf16_f32 v12, v12, v12
    v_and_b32 v12, s45, v12
    v_mul_f32 v12, 0x3db504f3, v12
    v_cvt_pk_bf16_f32 v12, v12, v12
    v_and_b32 v12, s45, v12
    v_mul_f32 v12, s46, v12
    s_nop 1
    v_max_f32_dpp v13, v12, v12 row_ror:8 row_mask:0xf bank_mask:0xf
    s_nop 1
    v_max_f32_dpp v13, v13, v13 row_ror:4 row_mask:0xf bank_mask:0xf
    s_nop 1
    v_max_f32_dpp v13, v13, v13 quad_perm:[1,0,3,2] row_mask:0xf bank_mask:0xf
    v_mov_b32 v14, v13
    s_nop 1
    v_permlane16_swap_b32 v13, v14
    v_max_f32 v13, v13, v14
    v_mov_b32 v14, v13
    s_nop 1
    v_permlane32_swap_b32 v13, v14
    v_max_f32 v13, v13, v14
    v_sub_f32 v12, v12, v13
    v_exp_f32 v12, v12
    v_mov_b32 v10, v13
    v_cvt_pk_bf16_f32 v15, v12, v12
    v_add_f32_dpp v13, v12, v12 row_ror:8 row_mask:0xf bank_mask:0xf
    s_nop 0
    v_and_b32_dpp v40, v15, v6 row_newbcast:0 row_mask:0xf bank_mask:0xf
    v_and_b32_dpp v41, v15, v7 row_newbcast:0 row_mask:0xf bank_mask:0xf
    v_and_b32_dpp v42, v15, v8 row_newbcast:0 row_mask:0xf bank_mask:0xf
    v_and_b32_dpp v43, v15, v9 row_newbcast:0 row_mask:0xf bank_mask:0xf
    v_add_f32_dpp v13, v13, v13 row_ror:4 row_mask:0xf bank_mask:0xf
    v_and_b32_dpp v44, v15, v6 row_newbcast:4 row_mask:0xf bank_mask:0xf
    v_and_b32_dpp v45, v15, v7 row_newbcast:4 row_mask:0xf bank_mask:0xf
    v_and_b32_dpp v46, v15, v8 row_newbcast:4 row_mask:0xf bank_mask:0xf
    v_and_b32_dpp v47, v15, v9 row_newbcast:4 row_mask:0xf bank_mask:0xf
    v_add_f32_dpp v13, v13, v13 quad_perm:[1,0,3,2] row_mask:0xf bank_mask:0xf
    v_and_b32_dpp v48, v15, v6 row_newbcast:8 row_mask:0xf bank_mask:0xf
    v_and_b32_dpp v49, v15, v7 row_newbcast:8 row_mask:0xf bank_mask:0xf
    v_and_b32_dpp v50, v15, v8 row_newbcast:8 row_mask:0xf bank_mask:0xf
    v_and_b32_dpp v51, v15, v9 row_newbcast:8 row_mask:0xf bank_mask:0xf
    v_mov_b32 v16, v13
    v_and_b32_dpp v52, v15, v6 row_newbcast:12 row_mask:0xf bank_mask:0xf
    v_and_b32_dpp v53, v15, v7 row_newbcast:12 row_mask:0xf bank_mask:0xf
    v_and_b32_dpp v54, v15, v8 row_newbcast:12 row_mask:0xf bank_mask:0xf
    v_and_b32_dpp v55, v15, v9 row_newbcast:12 row_mask:0xf bank_mask:0xf
    v_permlane16_swap_b32 v13, v16
    v_and_b32_dpp v56, v15, v6 row_newbcast:1 row_mask:0xf bank_mask:0xf
    v_and_b32_dpp v57, v15, v7 row_newbcast:1 row_mask:0xf bank_mask:0xf
    v_and_b32_dpp v58, v15, v8 row_newbcast:1 row_mask:0xf bank_mask:0xf
    v_and_b32_dpp v59, v15, v9 row_newbcast:1 row_mask:0xf bank_mask:0xf
    v_add_f32 v13, v13, v16
    v_and_b32_dpp v60, v15, v6 row_newbcast:5 row_mask:0xf bank_mask:0xf
    v_and_b32_dpp v61, v15, v7 row_newbcast:5 row_mask:0xf bank_mask:0xf
    v_and_b32_dpp v62, v15, v8 row_newbcast:5 row_mask:0xf bank_mask:0xf
    v_and_b32_dpp v63, v15, v9 row_newbcast:5 row_mask:0xf bank_mask:0xf
    v_mov_b32 v16, v13
    v_and_b32_dpp v64, v15, v6 row_newbcast:9 row_mask:0xf bank_mask:0xf
    v_and_b32_dpp v65, v15, v7 row_newbcast:9 row_mask:0xf bank_mask:0xf
    v_and_b32_dpp v66, v15, v8 row_newbcast:9 row_mask:0xf bank_mask:0xf
    v_and_b32_dpp v67, v15, v9 row_newbcast:9 row_mask:0xf bank_mask:0xf
    v_permlane32_swap_b32 v13, v16
    v_and_b32_dpp v68, v15, v6 row_newbcast:13 row_mask:0xf bank_mask:0xf
    v_and_b32_dpp v69, v15, v7 row_newbcast:13 row_mask:0xf bank_mask:0xf
    v_and_b32_dpp v70, v15, v8 row_newbcast:13 row_mask:0xf bank_mask:0xf
    v_and_b32_dpp v71, v15, v9 row_newbcast:13 row_mask:0xf bank_mask:0xf
    v_add_f32 v11, v13, v16
    v_mfma_f32_16x16x32_bf16 v[20:23], v[40:43], v[72:75], 0
    v_mfma_f32_16x16x32_bf16 v[20:23], v[44:47], v[76:79], v[20:23]
    v_mfma_f32_16x16x32_bf16 v[20:23], v[48:51], v[80:83], v[20:23]
    v_mfma_f32_16x16x32_bf16 v[20:23], v[52:55], v[84:87], v[20:23]
    v_mfma_f32_16x16x32_bf16 v[20:23], v[56:59], v[88:91], v[20:23]
    v_mfma_f32_16x16x32_bf16 v[20:23], v[60:63], v[92:95], v[20:23]
    v_mfma_f32_16x16x32_bf16 v[20:23], v[64:67], v[96:99], v[20:23]
    v_mfma_f32_16x16x32_bf16 v[20:23], v[68:71], v[100:103], v[20:23]
    v_xor_b32 v5, 786432, v5
    s_waitcnt vmcnt(0)
    global_load_dwordx4 v[136:139], v5, s[20:21] offset:0 nt
    global_load_dwordx4 v[140:143], v5, s[20:21] offset:256 nt
    global_load_dwordx4 v[144:147], v5, s[20:21] offset:512 nt
    global_load_dwordx4 v[148:151], v5, s[20:21] offset:768 nt
    v_mfma_f32_16x16x32_bf16 v[12:15], v[24:27], v[104:107], 0
    v_mfma_f32_16x16x32_bf16 v[12:15], v[28:31], v[108:111], v[12:15]
    v_mfma_f32_16x16x32_bf16 v[12:15], v[32:35], v[112:115], v[12:15]
    v_mfma_f32_16x16x32_bf16 v[12:15], v[36:39], v[116:119], v[12:15]
    v_mfma_f32_16x16x32_bf16 v[16:19], v[24:27], v[120:123], 0
    v_mfma_f32_16x16x32_bf16 v[16:19], v[28:31], v[124:127], v[16:19]
    v_mfma_f32_16x16x32_bf16 v[16:19], v[32:35], v[128:131], v[16:19]
    v_mfma_f32_16x16x32_bf16 v[16:19], v[36:39], v[132:135], v[16:19]
    s_nop 3
    v_mov_b32_dpp v0, v12 quad_perm:[0,0,0,0] row_mask:0xf bank_mask:0xf
    s_nop 2
    v_mov_b32_dpp v1, v16 quad_perm:[0,0,0,0] row_mask:0xf bank_mask:0xf
    v_add_f32_dpp v0, v13, v0 quad_perm:[1,1,1,1] row_mask:0xf bank_mask:0xf
    s_nop 0
    v_add_f32_dpp v1, v17, v1 quad_perm:[1,1,1,1] row_mask:0xf bank_mask:0xf
    v_add_f32_dpp v0, v14, v0 quad_perm:[2,2,2,2] row_mask:0xf bank_mask:0xf
    s_nop 0
    v_add_f32_dpp v1, v18, v1 quad_perm:[2,2,2,2] row_mask:0xf bank_mask:0xf
    v_add_f32_dpp v0, v15, v0 quad_perm:[3,3,3,3] row_mask:0xf bank_mask:0xf
    s_nop 0
    v_add_f32_dpp v1, v19, v1 quad_perm:[3,3,3,3] row_mask:0xf bank_mask:0xf
    v_cndmask_b32 v12, v0, v1, s[54:55]
    v_cvt_pk_bf16_f32 v12, v12, v12
    v_and_b32 v12, s45, v12
    v_mul_f32 v12, 0x3db504f3, v12
    v_cvt_pk_bf16_f32 v12, v12, v12
    v_and_b32 v12, s45, v12
    v_mul_f32 v12, s46, v12
    s_nop 1
    v_max_f32_dpp v13, v12, v12 row_ror:8 row_mask:0xf bank_mask:0xf
    s_nop 1
    v_max_f32_dpp v13, v13, v13 row_ror:4 row_mask:0xf bank_mask:0xf
    s_nop 1
    v_max_f32_dpp v13, v13, v13 quad_perm:[1,0,3,2] row_mask:0xf bank_mask:0xf
    v_mov_b32 v14, v13
    s_nop 1
    v_permlane16_swap_b32 v13, v14
    v_max_f32 v13, v13, v14
    v_mov_b32 v14, v13
    s_nop 1
    v_permlane32_swap_b32 v13, v14
    v_max_f32 v13, v13, v14
    v_max_f32 v13, v13, v10
    v_sub_f32 v14, v10, v13
    v_exp_f32 v14, v14
    v_sub_f32 v12, v12, v13
    v_exp_f32 v12, v12
    v_mov_b32 v10, v13
    v_mul_f32 v20, v14, v20
    v_mul_f32 v21, v14, v21
    v_mul_f32 v22, v14, v22
    v_mul_f32 v23, v14, v23
    v_cvt_pk_bf16_f32 v15, v12, v12
    v_add_f32_dpp v13, v12, v12 row_ror:8 row_mask:0xf bank_mask:0xf
    s_nop 0
    v_and_b32_dpp v104, v15, v6 row_newbcast:0 row_mask:0xf bank_mask:0xf
    v_and_b32_dpp v105, v15, v7 row_newbcast:0 row_mask:0xf bank_mask:0xf
    v_and_b32_dpp v106, v15, v8 row_newbcast:0 row_mask:0xf bank_mask:0xf
    v_and_b32_dpp v107, v15, v9 row_newbcast:0 row_mask:0xf bank_mask:0xf
    v_add_f32_dpp v13, v13, v13 row_ror:4 row_mask:0xf bank_mask:0xf
    v_and_b32_dpp v108, v15, v6 row_newbcast:4 row_mask:0xf bank_mask:0xf
    v_and_b32_dpp v109, v15, v7 row_newbcast:4 row_mask:0xf bank_mask:0xf
    v_and_b32_dpp v110, v15, v8 row_newbcast:4 row_mask:0xf bank_mask:0xf
    v_and_b32_dpp v111, v15, v9 row_newbcast:4 row_mask:0xf bank_mask:0xf
    v_add_f32_dpp v13, v13, v13 quad_perm:[1,0,3,2] row_mask:0xf bank_mask:0xf
    v_and_b32_dpp v112, v15, v6 row_newbcast:8 row_mask:0xf bank_mask:0xf
    v_and_b32_dpp v113, v15, v7 row_newbcast:8 row_mask:0xf bank_mask:0xf
    v_and_b32_dpp v114, v15, v8 row_newbcast:8 row_mask:0xf bank_mask:0xf
    v_and_b32_dpp v115, v15, v9 row_newbcast:8 row_mask:0xf bank_mask:0xf
    v_mov_b32 v16, v13
    v_and_b32_dpp v116, v15, v6 row_newbcast:12 row_mask:0xf bank_mask:0xf
    v_and_b32_dpp v117, v15, v7 row_newbcast:12 row_mask:0xf bank_mask:0xf
    v_and_b32_dpp v118, v15, v8 row_newbcast:12 row_mask:0xf bank_mask:0xf
    v_and_b32_dpp v119, v15, v9 row_newbcast:12 row_mask:0xf bank_mask:0xf
    v_permlane16_swap_b32 v13, v16
    v_and_b32_dpp v120, v15, v6 row_newbcast:1 row_mask:0xf bank_mask:0xf
    v_and_b32_dpp v121, v15, v7 row_newbcast:1 row_mask:0xf bank_mask:0xf
    v_and_b32_dpp v122, v15, v8 row_newbcast:1 row_mask:0xf bank_mask:0xf
    v_and_b32_dpp v123, v15, v9 row_newbcast:1 row_mask:0xf bank_mask:0xf
    v_add_f32 v13, v13, v16
    v_and_b32_dpp v124, v15, v6 row_newbcast:5 row_mask:0xf bank_mask:0xf
    v_and_b32_dpp v125, v15, v7 row_newbcast:5 row_mask:0xf bank_mask:0xf
    v_and_b32_dpp v126, v15, v8 row_newbcast:5 row_mask:0xf bank_mask:0xf
    v_and_b32_dpp v127, v15, v9 row_newbcast:5 row_mask:0xf bank_mask:0xf
    v_mov_b32 v16, v13
    v_and_b32_dpp v128, v15, v6 row_newbcast:9 row_mask:0xf bank_mask:0xf
    v_and_b32_dpp v129, v15, v7 row_newbcast:9 row_mask:0xf bank_mask:0xf
    v_and_b32_dpp v130, v15, v8 row_newbcast:9 row_mask:0xf bank_mask:0xf
    v_and_b32_dpp v131, v15, v9 row_newbcast:9 row_mask:0xf bank_mask:0xf
    v_permlane32_swap_b32 v13, v16
    v_and_b32_dpp v132, v15, v6 row_newbcast:13 row_mask:0xf bank_mask:0xf
    v_and_b32_dpp v133, v15, v7 row_newbcast:13 row_mask:0xf bank_mask:0xf
    v_and_b32_dpp v134, v15, v8 row_newbcast:13 row_mask:0xf bank_mask:0xf
    v_and_b32_dpp v135, v15, v9 row_newbcast:13 row_mask:0xf bank_mask:0xf
    v_add_f32 v13, v13, v16
    v_fma_f32 v11, v11, v14, v13
    s_lshl_b32 s8, s11, 3
    s_add_u32 s8, s8, 4096
    v_mov_b32 v12, s8
    ds_write_b64 v12, v[10:11]
    s_lshl_b32 s8, s11, 9
    v_lshlrev_b32 v8, 5, v2
    v_lshl_add_u32 v8, v3, 4, v8
    v_add_u32 v8, s8, v8
    v_xor_b32 v5, 262144, v5
    s_lshr_b32 s48, s3, 2
    s_xor_b32 s48, s48, 4
    s_or_b32 s48, s48, s11
    v_mov_b32 v37, 32768
    s_waitcnt vmcnt(0)
    s_cbranch_scc1 L_nch
    global_load_dwordx2 v[38:39], v37, s[40:41] sc1
L_nch:
    global_load_dwordx4 v[152:155], v5, s[20:21] offset:0 nt
    global_load_dwordx4 v[156:159], v5, s[20:21] offset:256 nt
    global_load_dwordx4 v[160:163], v5, s[20:21] offset:512 nt
    global_load_dwordx4 v[164:167], v5, s[20:21] offset:768 nt
    v_mov_b32 v12, 1
    v_mov_b32 v13, 4164
    s_mov_b64 exec, 1
    ds_add_u32 v13, v12
    s_mov_b64 exec, -1
    v_lshl_add_u32 v1, v3, 4, v2
    s_lshl_b32 s8, s3, 3
    s_add_u32 s8, s8, s11
    s_lshl_b32 s8, s8, 10
    s_add_u32 s8, s8, 524288
    v_lshl_add_u32 v4, v1, 4, s8
    s_mul_i32 s8, s11, 272
    s_add_u32 s8, s8, 24576
    v_lshl_add_u32 v5, v1, 3, s8
    s_add_u32 s6, s42, 0x9e3779b9
    s_and_b32 s6, s6, -16
    s_lshr_b32 s48, s3, 2
    s_xor_b32 s48, s48, 4
    s_or_b32 s48, s48, s11
    s_and_b32 s8, s3, 3
    s_mov_b32 s12, s4
    s_lshl_b32 s9, s12, 2
    s_add_u32 s9, s9, s8
    s_mov_b32 s59, s9
    s_lshl_b32 s9, s9, 5
    v_and_b32 v6, 7, v1
    v_lshl_add_u32 v24, v6, 2, s9
    v_lshrrev_b32 v7, 3, v1
    v_lshlrev_b32 v7, 9, v7
    v_lshl_add_u32 v7, v6, 4, v7
    s_lshl_b32 s8, s8, 7
    s_lshl_b32 s9, s12, 14
    s_add_u32 s8, s8, s9
    s_add_u32 s8, s8, 1052672
    v_add_u32 v25, s8, v7
    v_add_u32 v26, 0x2000, v25
    v_add_u32 v27, 131072, v25
    v_add_u32 v28, 131072, v26
    s_mul_i32 s8, s59, 16384
    s_add_u32 s8, s8, 1310720
    v_lshl_add_u32 v25, v1, 4, s8
    s_mov_b32 s54, 0
    s_mov_b32 s55, -1
    v_mfma_f32_16x16x32_bf16 v[20:23], v[104:107], v[136:139], v[20:23]
    v_mfma_f32_16x16x32_bf16 v[20:23], v[108:111], v[140:143], v[20:23]
    v_mfma_f32_16x16x32_bf16 v[20:23], v[112:115], v[144:147], v[20:23]
    v_mfma_f32_16x16x32_bf16 v[20:23], v[116:119], v[148:151], v[20:23]
    s_waitcnt vmcnt(3)
    v_mfma_f32_16x16x32_bf16 v[20:23], v[120:123], v[152:155], v[20:23]
    s_waitcnt vmcnt(2)
    v_mfma_f32_16x16x32_bf16 v[20:23], v[124:127], v[156:159], v[20:23]
    s_waitcnt vmcnt(1)
    v_mfma_f32_16x16x32_bf16 v[20:23], v[128:131], v[160:163], v[20:23]
    s_waitcnt vmcnt(0)
    v_mfma_f32_16x16x32_bf16 v[20:23], v[132:135], v[164:167], v[20:23]
    s_mov_b32 exec_hi, 0
    s_nop 6
    ds_write_b128 v8, v[20:23] offset:0
    s_mov_b32 exec_hi, -1
    s_cmp_lg_u32 s48, 0
    s_cbranch_scc1 L_nox
    s_branch L_cc1
L_cc:
    global_load_dwordx2 v[38:39], v37, s[40:41] sc1
    s_waitcnt vmcnt(0)
L_cc1:
    v_cmp_ne_u32 vcc, s6, v39
    s_cbranch_vccz L_cc_ok
    s_sub_u32 s7, s7, 1
    s_cbranch_scc1 L_end
    s_sleep 1
    s_nop 0
    s_branch L_cc
L_cc_ok:
    v_and_b32 v38, 0x2000, v38
    v_add_u32 v25, v25, v38
    global_load_dword v29, v24, s[16:17]
    global_load_dword v30, v24, s[34:35]
    global_load_dword v31, v24, s[36:37]
    global_load_dwordx4 v[64:67], v27, s[40:41] offset:-4096 sc1
    global_load_dwordx4 v[68:71], v27, s[40:41] sc1
    global_load_dwordx4 v[72:75], v28, s[40:41] offset:-4096 sc1
    global_load_dwordx4 v[76:79], v28, s[40:41] sc1
    global_load_dwordx4 v[80:83], v25, s[40:41] offset:0 sc1
    global_load_dwordx4 v[84:87], v25, s[40:41] offset:1024 sc1
    global_load_dwordx4 v[88:91], v25, s[40:41] offset:2048 sc1
    global_load_dwordx4 v[92:95], v25, s[40:41] offset:3072 sc1
L_nox:
    s_waitcnt lgkmcnt(0)
    s_barrier
    s_barrier
    s_cmp_eq_u32 s11, s4
    s_cbranch_scc1 L_pb_done
    s_mov_b32 exec_hi, 1
    global_load_dwordx4 v[40:43], v4, s[40:41] sc1
L_pb:
    s_waitcnt vmcnt(0)
    v_xor_b32 v12, s6, v41
    v_bitop3_b32 v12, v12, v43, s6 bitop3:0xf6
    v_cmp_ne_u32 vcc, 0, v12
    s_cbranch_vccz L_pb_ok0
    global_load_dwordx4 v[40:43], v4, s[40:41] sc1
    s_sub_u32 s7, s7, 1
    s_nop 0
    s_cbranch_scc0 L_pb
    s_branch L_end
L_pb_ok0:
    ds_write2_b32 v5, v40, v42 offset1:1
L_pb_done:
    s_cmp_lg_u32 s48, 0
    s_waitcnt lgkmcnt(0)
    s_barrier
    s_cbranch_scc1 L_end
    s_mov_b32 exec_hi, -1
    global_load_dwordx4 v[80:83], v25, s[40:41] offset:0 sc1
    global_load_dwordx4 v[84:87], v25, s[40:41] offset:1024 sc1
    global_load_dwordx4 v[88:91], v25, s[40:41] offset:2048 sc1
    global_load_dwordx4 v[92:95], v25, s[40:41] offset:3072 sc1
    s_waitcnt vmcnt(4)
    s_branch L_pu1
L_pu:
    global_load_dwordx4 v[64:67], v27, s[40:41] offset:-4096 sc1
    global_load_dwordx4 v[68:71], v27, s[40:41] sc1
    global_load_dwordx4 v[72:75], v28, s[40:41] offset:-4096 sc1
    global_load_dwordx4 v[76:79], v28, s[40:41] sc1
    s_waitcnt vmcnt(0)
L_pu1:
    v_xor_b32 v12, s6, v65
    v_bitop3_b32 v12, v12, v67, s6 bitop3:0xf6
    v_bitop3_b32 v12, v12, v69, s6 bitop3:0xf6
    v_bitop3_b32 v12, v12, v71, s6 bitop3:0xf6
    v_bitop3_b32 v12, v12, v73, s6 bitop3:0xf6
    v_bitop3_b32 v12, v12, v75, s6 bitop3:0xf6
    v_bitop3_b32 v12, v12, v77, s6 bitop3:0xf6
    v_bitop3_b32 v12, v12, v79, s6 bitop3:0xf6
    v_cmp_ne_u32 vcc, 0, v12
    s_cbranch_vccz L_pu_ok
    s_sub_u32 s7, s7, 1
    s_cbranch_scc1 L_end
    s_nop 0
    s_branch L_pu
L_pu_ok:
    v_lshlrev_b32 v32, 16, v30
    v_and_b32 v33, s45, v30
    v_lshlrev_b32 v34, 16, v29
    v_and_b32 v35, s45, v29
    v_cndmask_b32 v32, v32, v33, s[54:55]
    v_cndmask_b32 v34, v34, v35, s[54:55]
    v_add_f32 v12, v64, v68
    v_add_f32 v13, v66, v70
    v_add_f32 v14, v72, v76
    v_add_f32 v15, v74, v78
    v_add_f32 v12, v12, v14
    v_add_f32 v13, v13, v15
    s_nop 1
    v_permlane32_swap_b32 v12, v13
    v_add_f32 v12, v12, v13
    v_mov_b32 v13, v12
    s_nop 1
    v_permlane16_swap_b32 v12, v13
    v_add_f32 v12, v12, v13
    s_nop 1
    v_add_f32_dpp v12, v12, v12 row_ror:8 row_mask:0xf bank_mask:0xf
    v_cvt_pk_bf16_f32 v12, v12, v12
    v_and_b32 v12, s45, v12
    v_add_f32 v32, v32, v12
    v_cvt_pk_bf16_f32 v32, v32, v32
    v_and_b32 v32, s45, v32
    v_mul_f32 v33, 0xbfb8aa3b, v32
    v_exp_f32 v33, v33
    s_nop 0
    v_add_f32 v33, 1.0, v33
    v_rcp_f32 v33, v33
    s_nop 0
    v_mul_f32 v32, v32, v33
    v_cvt_pk_bf16_f32 v32, v32, v32
    v_and_b32 v32, s45, v32
    v_lshrrev_b32 v33, 4, v1
    v_and_b32 v33, 2, v33
    v_add_u32 v24, v24, v33
    v_mov_b32 v35, 0
    v_mov_b32 v36, s6
    s_barrier
    global_load_dwordx4 v[96:99], v25, s[40:41] offset:0 sc1
    global_load_dwordx4 v[100:103], v25, s[40:41] offset:1024 sc1
    global_load_dwordx4 v[104:107], v25, s[40:41] offset:2048 sc1
    global_load_dwordx4 v[108:111], v25, s[40:41] offset:3072 sc1
    global_load_dwordx4 v[112:115], v25, s[40:41] offset:0 sc1
    global_load_dwordx4 v[116:119], v25, s[40:41] offset:1024 sc1
    global_load_dwordx4 v[120:123], v25, s[40:41] offset:2048 sc1
    global_load_dwordx4 v[124:127], v25, s[40:41] offset:3072 sc1
    global_load_dwordx4 v[128:131], v25, s[40:41] offset:0 sc1
    global_load_dwordx4 v[132:135], v25, s[40:41] offset:1024 sc1
    global_load_dwordx4 v[136:139], v25, s[40:41] offset:2048 sc1
    global_load_dwordx4 v[140:143], v25, s[40:41] offset:3072 sc1
L_ps:
    s_waitcnt vmcnt(12)
    v_xor_b32 v16, s6, v81
    v_bitop3_b32 v16, v16, v83, s6 bitop3:0xf6
    v_bitop3_b32 v16, v16, v85, s6 bitop3:0xf6
    v_bitop3_b32 v16, v16, v87, s6 bitop3:0xf6
    v_bitop3_b32 v16, v16, v89, s6 bitop3:0xf6
    v_bitop3_b32 v16, v16, v91, s6 bitop3:0xf6
    v_bitop3_b32 v16, v16, v93, s6 bitop3:0xf6
    v_bitop3_b32 v16, v16, v95, s6 bitop3:0xf6
    v_cmp_ne_u32 vcc, 0, v16
    v_add_f32 v12, v80, v84
    v_add_f32 v13, v82, v86
    v_add_f32 v14, v88, v92
    v_add_f32 v15, v90, v94
    s_cbranch_vccz L_ps_ok
    global_load_dwordx4 v[80:83], v25, s[40:41] offset:0 sc1
    global_load_dwordx4 v[84:87], v25, s[40:41] offset:1024 sc1
    global_load_dwordx4 v[88:91], v25, s[40:41] offset:2048 sc1
    global_load_dwordx4 v[92:95], v25, s[40:41] offset:3072 sc1
    s_waitcnt vmcnt(12)
    v_xor_b32 v16, s6, v97
    v_bitop3_b32 v16, v16, v99, s6 bitop3:0xf6
    v_bitop3_b32 v16, v16, v101, s6 bitop3:0xf6
    v_bitop3_b32 v16, v16, v103, s6 bitop3:0xf6
    v_bitop3_b32 v16, v16, v105, s6 bitop3:0xf6
    v_bitop3_b32 v16, v16, v107, s6 bitop3:0xf6
    v_bitop3_b32 v16, v16, v109, s6 bitop3:0xf6
    v_bitop3_b32 v16, v16, v111, s6 bitop3:0xf6
    v_cmp_ne_u32 vcc, 0, v16
    v_add_f32 v12, v96, v100
    v_add_f32 v13, v98, v102
    v_add_f32 v14, v104, v108
    v_add_f32 v15, v106, v110
    s_cbranch_vccz L_ps_ok
    global_load_dwordx4 v[96:99], v25, s[40:41] offset:0 sc1
    global_load_dwordx4 v[100:103], v25, s[40:41] offset:1024 sc1
    global_load_dwordx4 v[104:107], v25, s[40:41] offset:2048 sc1
    global_load_dwordx4 v[108:111], v25, s[40:41] offset:3072 sc1
    s_waitcnt vmcnt(12)
    v_xor_b32 v16, s6, v113
    v_bitop3_b32 v16, v16, v115, s6 bitop3:0xf6
    v_bitop3_b32 v16, v16, v117, s6 bitop3:0xf6
    v_bitop3_b32 v16, v16, v119, s6 bitop3:0xf6
    v_bitop3_b32 v16, v16, v121, s6 bitop3:0xf6
    v_bitop3_b32 v16, v16, v123, s6 bitop3:0xf6
    v_bitop3_b32 v16, v16, v125, s6 bitop3:0xf6
    v_bitop3_b32 v16, v16, v127, s6 bitop3:0xf6
    v_cmp_ne_u32 vcc, 0, v16
    v_add_f32 v12, v112, v116
    v_add_f32 v13, v114, v118
    v_add_f32 v14, v120, v124
    v_add_f32 v15, v122, v126
    s_cbranch_vccz L_ps_ok
    global_load_dwordx4 v[112:115], v25, s[40:41] offset:0 sc1
    global_load_dwordx4 v[116:119], v25, s[40:41] offset:1024 sc1
    global_load_dwordx4 v[120:123], v25, s[40:41] offset:2048 sc1
    global_load_dwordx4 v[124:127], v25, s[40:41] offset:3072 sc1
    s_waitcnt vmcnt(12)
    v_xor_b32 v16, s6, v129
    v_bitop3_b32 v16, v16, v131, s6 bitop3:0xf6
    v_bitop3_b32 v16, v16, v133, s6 bitop3:0xf6
    v_bitop3_b32 v16, v16, v135, s6 bitop3:0xf6
    v_bitop3_b32 v16, v16, v137, s6 bitop3:0xf6
    v_bitop3_b32 v16, v16, v139, s6 bitop3:0xf6
    v_bitop3_b32 v16, v16, v141, s6 bitop3:0xf6
    v_bitop3_b32 v16, v16, v143, s6 bitop3:0xf6
    v_cmp_ne_u32 vcc, 0, v16
    v_add_f32 v12, v128, v132
    v_add_f32 v13, v130, v134
    v_add_f32 v14, v136, v140
    v_add_f32 v15, v138, v142
    s_cbranch_vccz L_ps_ok
    global_load_dwordx4 v[128:131], v25, s[40:41] offset:0 sc1
    global_load_dwordx4 v[132:135], v25, s[40:41] offset:1024 sc1
    global_load_dwordx4 v[136:139], v25, s[40:41] offset:2048 sc1
    global_load_dwordx4 v[140:143], v25, s[40:41] offset:3072 sc1
    s_sub_u32 s7, s7, 1
    s_cbranch_scc0 L_ps
    s_branch L_end
L_ps_ok:
    v_add_f32 v12, v12, v14
    v_add_f32 v13, v13, v15
    s_nop 1
    v_permlane32_swap_b32 v12, v13
    v_add_f32 v12, v12, v13
    v_mov_b32 v13, v12
    s_nop 1
    v_permlane16_swap_b32 v12, v13
    v_add_f32 v12, v12, v13
    s_nop 1
    v_add_f32_dpp v12, v12, v12 row_ror:8 row_mask:0xf bank_mask:0xf
    v_cvt_pk_bf16_f32 v12, v12, v12
    v_and_b32 v12, s45, v12
    v_mul_f32 v12, v12, v32
    v_cvt_pk_bf16_f32 v12, v12, v12
    v_and_b32 v12, s45, v12
    v_add_f32 v12, v12, v34
    v_cvt_pk_bf16_f32 v12, v12, v12
    s_mov_b32 exec_lo, 0xff
    s_mov_b32 exec_hi, 0xff
    global_store_short v24, v12, s[36:37] nt
    s_cmp_lg_u32 s59, 0
    s_cbranch_scc1 L_end
    s_mov_b64 exec, 1
    global_store_dword v35, v36, s[40:41]
    s_branch L_end
L_q:
    s_lshl_b32 s10, s3, 3
    s_add_u32 s10, s10, s4
    s_mov_b32 s45, 0xffff0000
    s_mov_b32 s7, 1048576
    s_load_dword s42, s[40:41], 0
    v_and_b32 v4, 1, v3
    v_lshlrev_b32 v4, 3, v4
    v_lshl_add_u32 v4, v2, 4, v4
    v_lshrrev_b32 v6, 1, v3
    v_lshl_add_u32 v4, v6, 2, v4
    v_and_b32 v32, 1, v2
    v_lshlrev_b32 v32, 4, v32
    v_mov_b32 v33, 0xffff
    v_lshlrev_b32 v32, v32, v33
    v_lshrrev_b32 v33, 1, v2
    v_cmp_eq_u32 vcc, 0, v33
    s_nop 1
    v_cndmask_b32 v28, 0, v32, vcc
    v_cmp_eq_u32 vcc, 1, v33
    s_nop 1
    v_cndmask_b32 v29, 0, v32, vcc
    v_cmp_eq_u32 vcc, 2, v33
    s_nop 1
    v_cndmask_b32 v30, 0, v32, vcc
    v_cmp_eq_u32 vcc, 3, v33
    s_nop 1
    v_cndmask_b32 v31, 0, v32, vcc
    s_waitcnt vmcnt(16)
    v_lshlrev_b32 v12, 16, v8
    v_and_b32 v13, s45, v8
    v_lshlrev_b32 v14, 16, v9
    v_and_b32 v15, s45, v9
    v_lshlrev_b32 v16, 16, v10
    v_and_b32 v17, s45, v10
    v_lshlrev_b32 v18, 16, v11
    v_and_b32 v19, s45, v11
    v_add_f32 v20, v12, v13
    v_add_f32 v21, v14, v15
    v_add_f32 v22, v16, v17
    v_add_f32 v23, v18, v19
    v_add_f32 v20, v20, v21
    v_add_f32 v22, v22, v23
    v_add_f32 v20, v20, v22
    s_nop 1
    v_add_f32_dpp v20, v20, v20 row_ror:8 row_mask:0xf bank_mask:0xf
    s_nop 1
    v_add_f32_dpp v20, v20, v20 row_ror:4 row_mask:0xf bank_mask:0xf
    s_nop 1
    v_add_f32_dpp v20, v20, v20 row_ror:2 row_mask:0xf bank_mask:0xf
    s_nop 1
    v_add_f32_dpp v20, v20, v20 row_ror:1 row_mask:0xf bank_mask:0xf
    v_mov_b32 v21, v20
    s_nop 1
    v_permlane16_swap_b32 v20, v21
    v_add_f32 v20, v20, v21
    v_mov_b32 v21, v20
    s_nop 1
    v_permlane32_swap_b32 v20, v21
    v_add_f32 v20, v20, v21
    v_mul_f32 v20, 0x3b000000, v20
    v_sub_f32 v22, v12, v20
    v_mul_f32 v23, v22, v22
    v_sub_f32 v22, v13, v20
    v_fmac_f32 v23, v22, v22
    v_sub_f32 v22, v14, v20
    v_fmac_f32 v23, v22, v22
    v_sub_f32 v22, v15, v20
    v_fmac_f32 v23, v22, v22
    v_sub_f32 v22, v16, v20
    v_fmac_f32 v23, v22, v22
    v_sub_f32 v22, v17, v20
    v_fmac_f32 v23, v22, v22
    v_sub_f32 v22, v18, v20
    v_fmac_f32 v23, v22, v22
    v_sub_f32 v22, v19, v20
    v_fmac_f32 v23, v22, v22
    s_nop 1
    v_add_f32_dpp v23, v23, v23 row_ror:8 row_mask:0xf bank_mask:0xf
    s_nop 1
    v_add_f32_dpp v23, v23, v23 row_ror:4 row_mask:0xf bank_mask:0xf
    s_nop 1
    v_add_f32_dpp v23, v23, v23 row_ror:2 row_mask:0xf bank_mask:0xf
    s_nop 1
    v_add_f32_dpp v23, v23, v23 row_ror:1 row_mask:0xf bank_mask:0xf
    v_mov_b32 v21, v23
    s_nop 1
    v_permlane16_swap_b32 v23, v21
    v_add_f32 v23, v23, v21
    v_mov_b32 v21, v23
    s_nop 1
    v_permlane32_swap_b32 v23, v21
    v_add_f32 v23, v23, v21
    v_mul_f32 v23, 0x3b000000, v23
    v_cvt_pk_bf16_f32 v20, v20, v20
    v_and_b32 v20, s45, v20
    v_cvt_pk_bf16_f32 v23, v23, v23
    v_and_b32 v23, s45, v23
    v_add_f32 v23, 0x3727c5ac, v23
    v_cvt_pk_bf16_f32 v23, v23, v23
    v_and_b32 v23, s45, v23
    v_sqrt_f32 v23, v23
    s_nop 0
    v_cvt_pk_bf16_f32 v23, v23, v23
    v_and_b32 v23, s45, v23
    v_rcp_f32 v24, v23
    v_sub_f32 v12, v12, v20
    v_sub_f32 v13, v13, v20
    v_cvt_pk_bf16_f32 v13, v12, v13
    v_lshlrev_b32 v12, 16, v13
    v_and_b32 v13, s45, v13
    v_mul_f32 v25, v12, v24
    v_mul_f32 v26, v13, v24
    v_fma_f32 v12, -v25, v23, v12
    v_fma_f32 v13, -v26, v23, v13
    v_fmac_f32 v25, v12, v24
    v_fmac_f32 v26, v13, v24
    v_cvt_pk_bf16_f32 v8, v25, v26
    v_sub_f32 v14, v14, v20
    v_sub_f32 v15, v15, v20
    v_cvt_pk_bf16_f32 v15, v14, v15
    v_lshlrev_b32 v14, 16, v15
    v_and_b32 v15, s45, v15
    v_mul_f32 v25, v14, v24
    v_mul_f32 v26, v15, v24
    v_fma_f32 v14, -v25, v23, v14
    v_fma_f32 v15, -v26, v23, v15
    v_fmac_f32 v25, v14, v24
    v_fmac_f32 v26, v15, v24
    v_cvt_pk_bf16_f32 v9, v25, v26
    v_sub_f32 v16, v16, v20
    v_sub_f32 v17, v17, v20
    v_cvt_pk_bf16_f32 v17, v16, v17
    v_lshlrev_b32 v16, 16, v17
    v_and_b32 v17, s45, v17
    v_mul_f32 v25, v16, v24
    v_mul_f32 v26, v17, v24
    v_fma_f32 v16, -v25, v23, v16
    v_fma_f32 v17, -v26, v23, v17
    v_fmac_f32 v25, v16, v24
    v_fmac_f32 v26, v17, v24
    v_cvt_pk_bf16_f32 v10, v25, v26
    v_sub_f32 v18, v18, v20
    v_sub_f32 v19, v19, v20
    v_cvt_pk_bf16_f32 v19, v18, v19
    v_lshlrev_b32 v18, 16, v19
    v_and_b32 v19, s45, v19
    v_mul_f32 v25, v18, v24
    v_mul_f32 v26, v19, v24
    v_fma_f32 v18, -v25, v23, v18
    v_fma_f32 v19, -v26, v23, v19
    v_fmac_f32 v25, v18, v24
    v_fmac_f32 v26, v19, v24
    v_cvt_pk_bf16_f32 v11, v25, v26
    ds_write_b128 v5, v[8:11] offset:4608
    s_lshl_b32 s8, s4, 7
    v_lshl_add_u32 v6, v1, 1, s8
    ds_read_u16 v12, v6 offset:4608
    s_waitcnt lgkmcnt(0)
    s_add_u32 s6, s42, 0x9e3779b9
    s_and_b32 s6, s6, -16
    s_getreg_b32 s49, hwreg(HW_REG_XCC_ID, 0, 4)
    s_or_b32 s49, s49, s6
    v_lshl_or_b32 v12, v12, 16, v12
    s_nop 1
    v_and_b32_dpp v40, v12, v28 row_newbcast:0 row_mask:0xf bank_mask:0xf
    v_and_b32_dpp v41, v12, v29 row_newbcast:0 row_mask:0xf bank_mask:0xf
    v_and_b32_dpp v42, v12, v30 row_newbcast:0 row_mask:0xf bank_mask:0xf
    v_and_b32_dpp v43, v12, v31 row_newbcast:0 row_mask:0xf bank_mask:0xf
    v_and_b32_dpp v44, v12, v28 row_newbcast:1 row_mask:0xf bank_mask:0xf
    v_and_b32_dpp v45, v12, v29 row_newbcast:1 row_mask:0xf bank_mask:0xf
    v_and_b32_dpp v46, v12, v30 row_newbcast:1 row_mask:0xf bank_mask:0xf
    v_and_b32_dpp v47, v12, v31 row_newbcast:1 row_mask:0xf bank_mask:0xf
    s_waitcnt vmcnt(15)
    v_mfma_f32_16x16x32_bf16 v[20:23], v[40:43], v[104:107], 0
    v_and_b32_dpp v48, v12, v28 row_newbcast:2 row_mask:0xf bank_mask:0xf
    v_and_b32_dpp v49, v12, v29 row_newbcast:2 row_mask:0xf bank_mask:0xf
    v_and_b32_dpp v50, v12, v30 row_newbcast:2 row_mask:0xf bank_mask:0xf
    v_and_b32_dpp v51, v12, v31 row_newbcast:2 row_mask:0xf bank_mask:0xf
    s_waitcnt vmcnt(14)
    v_mfma_f32_16x16x32_bf16 v[20:23], v[44:47], v[108:111], v[20:23]
    v_and_b32_dpp v52, v12, v28 row_newbcast:3 row_mask:0xf bank_mask:0xf
    v_and_b32_dpp v53, v12, v29 row_newbcast:3 row_mask:0xf bank_mask:0xf
    v_and_b32_dpp v54, v12, v30 row_newbcast:3 row_mask:0xf bank_mask:0xf
    v_and_b32_dpp v55, v12, v31 row_newbcast:3 row_mask:0xf bank_mask:0xf
    s_waitcnt vmcnt(13)
    v_mfma_f32_16x16x32_bf16 v[20:23], v[48:51], v[112:115], v[20:23]
    v_and_b32_dpp v56, v12, v28 row_newbcast:4 row_mask:0xf bank_mask:0xf
    v_and_b32_dpp v57, v12, v29 row_newbcast:4 row_mask:0xf bank_mask:0xf
    v_and_b32_dpp v58, v12, v30 row_newbcast:4 row_mask:0xf bank_mask:0xf
    v_and_b32_dpp v59, v12, v31 row_newbcast:4 row_mask:0xf bank_mask:0xf
    s_waitcnt vmcnt(12)
    v_mfma_f32_16x16x32_bf16 v[20:23], v[52:55], v[116:119], v[20:23]
    v_and_b32_dpp v60, v12, v28 row_newbcast:5 row_mask:0xf bank_mask:0xf
    v_and_b32_dpp v61, v12, v29 row_newbcast:5 row_mask:0xf bank_mask:0xf
    v_and_b32_dpp v62, v12, v30 row_newbcast:5 row_mask:0xf bank_mask:0xf
    v_and_b32_dpp v63, v12, v31 row_newbcast:5 row_mask:0xf bank_mask:0xf
    s_waitcnt vmcnt(11)
    v_mfma_f32_16x16x32_bf16 v[20:23], v[56:59], v[120:123], v[20:23]
    v_and_b32_dpp v64, v12, v28 row_newbcast:6 row_mask:0xf bank_mask:0xf
    v_and_b32_dpp v65, v12, v29 row_newbcast:6 row_mask:0xf bank_mask:0xf
    v_and_b32_dpp v66, v12, v30 row_newbcast:6 row_mask:0xf bank_mask:0xf
    v_and_b32_dpp v67, v12, v31 row_newbcast:6 row_mask:0xf bank_mask:0xf
    s_waitcnt vmcnt(10)
    v_mfma_f32_16x16x32_bf16 v[20:23], v[60:63], v[124:127], v[20:23]
    v_and_b32_dpp v68, v12, v28 row_newbcast:7 row_mask:0xf bank_mask:0xf
    v_and_b32_dpp v69, v12, v29 row_newbcast:7 row_mask:0xf bank_mask:0xf
    v_and_b32_dpp v70, v12, v30 row_newbcast:7 row_mask:0xf bank_mask:0xf
    v_and_b32_dpp v71, v12, v31 row_newbcast:7 row_mask:0xf bank_mask:0xf
    s_waitcnt vmcnt(9)
    v_mfma_f32_16x16x32_bf16 v[20:23], v[64:67], v[128:131], v[20:23]
    v_and_b32_dpp v72, v12, v28 row_newbcast:8 row_mask:0xf bank_mask:0xf
    v_and_b32_dpp v73, v12, v29 row_newbcast:8 row_mask:0xf bank_mask:0xf
    v_and_b32_dpp v74, v12, v30 row_newbcast:8 row_mask:0xf bank_mask:0xf
    v_and_b32_dpp v75, v12, v31 row_newbcast:8 row_mask:0xf bank_mask:0xf
    s_waitcnt vmcnt(8)
    v_mfma_f32_16x16x32_bf16 v[20:23], v[68:71], v[132:135], v[20:23]
    v_and_b32_dpp v76, v12, v28 row_newbcast:9 row_mask:0xf bank_mask:0xf
    v_and_b32_dpp v77, v12, v29 row_newbcast:9 row_mask:0xf bank_mask:0xf
    v_and_b32_dpp v78, v12, v30 row_newbcast:9 row_mask:0xf bank_mask:0xf
    v_and_b32_dpp v79, v12, v31 row_newbcast:9 row_mask:0xf bank_mask:0xf
    s_waitcnt vmcnt(7)
    v_mfma_f32_16x16x32_bf16 v[20:23], v[72:75], v[136:139], v[20:23]
    v_and_b32_dpp v80, v12, v28 row_newbcast:10 row_mask:0xf bank_mask:0xf
    v_and_b32_dpp v81, v12, v29 row_newbcast:10 row_mask:0xf bank_mask:0xf
    v_and_b32_dpp v82, v12, v30 row_newbcast:10 row_mask:0xf bank_mask:0xf
    v_and_b32_dpp v83, v12, v31 row_newbcast:10 row_mask:0xf bank_mask:0xf
    s_waitcnt vmcnt(6)
    v_mfma_f32_16x16x32_bf16 v[20:23], v[76:79], v[140:143], v[20:23]
    v_and_b32_dpp v84, v12, v28 row_newbcast:11 row_mask:0xf bank_mask:0xf
    v_and_b32_dpp v85, v12, v29 row_newbcast:11 row_mask:0xf bank_mask:0xf
    v_and_b32_dpp v86, v12, v30 row_newbcast:11 row_mask:0xf bank_mask:0xf
    v_and_b32_dpp v87, v12, v31 row_newbcast:11 row_mask:0xf bank_mask:0xf
    s_waitcnt vmcnt(5)
    v_mfma_f32_16x16x32_bf16 v[20:23], v[80:83], v[144:147], v[20:23]
    v_and_b32_dpp v88, v12, v28 row_newbcast:12 row_mask:0xf bank_mask:0xf
    v_and_b32_dpp v89, v12, v29 row_newbcast:12 row_mask:0xf bank_mask:0xf
    v_and_b32_dpp v90, v12, v30 row_newbcast:12 row_mask:0xf bank_mask:0xf
    v_and_b32_dpp v91, v12, v31 row_newbcast:12 row_mask:0xf bank_mask:0xf
    s_waitcnt vmcnt(4)
    v_mfma_f32_16x16x32_bf16 v[20:23], v[84:87], v[148:151], v[20:23]
    v_and_b32_dpp v92, v12, v28 row_newbcast:13 row_mask:0xf bank_mask:0xf
    v_and_b32_dpp v93, v12, v29 row_newbcast:13 row_mask:0xf bank_mask:0xf
    v_and_b32_dpp v94, v12, v30 row_newbcast:13 row_mask:0xf bank_mask:0xf
    v_and_b32_dpp v95, v12, v31 row_newbcast:13 row_mask:0xf bank_mask:0xf
    s_waitcnt vmcnt(3)
    v_mfma_f32_16x16x32_bf16 v[20:23], v[88:91], v[152:155], v[20:23]
    v_and_b32_dpp v96, v12, v28 row_newbcast:14 row_mask:0xf bank_mask:0xf
    v_and_b32_dpp v97, v12, v29 row_newbcast:14 row_mask:0xf bank_mask:0xf
    v_and_b32_dpp v98, v12, v30 row_newbcast:14 row_mask:0xf bank_mask:0xf
    v_and_b32_dpp v99, v12, v31 row_newbcast:14 row_mask:0xf bank_mask:0xf
    s_waitcnt vmcnt(2)
    v_mfma_f32_16x16x32_bf16 v[20:23], v[92:95], v[156:159], v[20:23]
    v_and_b32_dpp v100, v12, v28 row_newbcast:15 row_mask:0xf bank_mask:0xf
    v_and_b32_dpp v101, v12, v29 row_newbcast:15 row_mask:0xf bank_mask:0xf
    v_and_b32_dpp v102, v12, v30 row_newbcast:15 row_mask:0xf bank_mask:0xf
    v_and_b32_dpp v103, v12, v31 row_newbcast:15 row_mask:0xf bank_mask:0xf
    s_waitcnt vmcnt(1)
    v_mfma_f32_16x16x32_bf16 v[20:23], v[96:99], v[160:163], v[20:23]
    s_waitcnt vmcnt(0)
    v_mfma_f32_16x16x32_bf16 v[20:23], v[100:103], v[164:167], v[20:23]
    s_lshl_b32 s8, s10, 10
    s_add_u32 s8, s8, 65536
    v_add_u32 v7, s8, v5
    v_mov_b32 v25, s49
    v_mov_b32 v27, s49
    s_lshl_b32 s8, s3, 13
    s_add_u32 s8, s8, 69632
    v_add_u32 v6, s8, v5
    v_permlane32_swap_b32 v20, v22
    v_permlane32_swap_b32 v21, v23
    v_mov_b32 v24, v20
    v_mov_b32 v26, v21
    global_store_dwordx4 v7, v[24:27], s[40:41]
    s_mov_b32 s48, 0
    v_mov_b32 v62, 4168
L_pqw:
    ds_read_b32 v63, v62
    s_waitcnt lgkmcnt(0)
    v_cmp_gt_u32 vcc, 8, v63
    s_cbranch_vccz L_pqw_ok
    s_sub_u32 s7, s7, 1
    s_cbranch_scc1 L_end
    s_sleep 4
    s_branch L_pqw
L_pqw_ok:
    s_mov_b32 s14, 3
L_pq:
    global_load_dwordx4 v[28:31], v6, s[40:41] offset:-4096 sc1
    global_load_dwordx4 v[32:35], v6, s[40:41] offset:-3072 sc1
    global_load_dwordx4 v[36:39], v6, s[40:41] offset:-2048 sc1
    global_load_dwordx4 v[40:43], v6, s[40:41] offset:-1024 sc1
    global_load_dwordx4 v[44:47], v6, s[40:41] offset:0 sc1
    global_load_dwordx4 v[48:51], v6, s[40:41] offset:1024 sc1
    global_load_dwordx4 v[52:55], v6, s[40:41] offset:2048 sc1
    global_load_dwordx4 v[56:59], v6, s[40:41] offset:3072 sc1
    s_waitcnt vmcnt(0)
    v_xor_b32 v60, s49, v29
    v_bitop3_b32 v60, v60, v31, s49 bitop3:0xf6
    v_bitop3_b32 v60, v60, v33, s49 bitop3:0xf6
    v_bitop3_b32 v60, v60, v35, s49 bitop3:0xf6
    v_bitop3_b32 v60, v60, v37, s49 bitop3:0xf6
    v_bitop3_b32 v60, v60, v39, s49 bitop3:0xf6
    v_bitop3_b32 v60, v60, v41, s49 bitop3:0xf6
    v_bitop3_b32 v60, v60, v43, s49 bitop3:0xf6
    v_bitop3_b32 v60, v60, v45, s49 bitop3:0xf6
    v_bitop3_b32 v60, v60, v47, s49 bitop3:0xf6
    v_bitop3_b32 v60, v60, v49, s49 bitop3:0xf6
    v_bitop3_b32 v60, v60, v51, s49 bitop3:0xf6
    v_bitop3_b32 v60, v60, v53, s49 bitop3:0xf6
    v_bitop3_b32 v60, v60, v55, s49 bitop3:0xf6
    v_bitop3_b32 v60, v60, v57, s49 bitop3:0xf6
    v_bitop3_b32 v60, v60, v59, s49 bitop3:0xf6
    v_cmp_ne_u32 vcc, 0, v60
    s_cbranch_vccz L_pq_ok
    v_cmp_lt_u32 vcc, 15, v60
    s_cbranch_vccz L_pq_far
    s_cmp_lg_u32 s14, 0
    s_cbranch_scc1 L_pq_r
    global_store_dwordx4 v7, v[24:27], s[40:41] sc1
L_pq_r:
    s_sub_u32 s14, s14, 1
    s_sub_u32 s7, s7, 1
    s_cbranch_scc1 L_end
    s_sleep 1
    s_branch L_pq
L_pq_far:
    global_store_dwordx4 v7, v[24:27], s[40:41] sc1
    s_mov_b32 s48, 1
L_pq_ok:
    v_add_f32 v28, v28, v32
    v_add_f32 v36, v36, v40
    v_add_f32 v44, v44, v48
    v_add_f32 v52, v52, v56
    v_add_f32 v28, v28, v36
    v_add_f32 v44, v44, v52
    v_add_f32 v28, v28, v44
    v_add_f32 v30, v30, v34
    v_add_f32 v38, v38, v42
    v_add_f32 v46, v46, v50
    v_add_f32 v54, v54, v58
    v_add_f32 v30, v30, v38
    v_add_f32 v46, v46, v54
    v_add_f32 v30, v30, v46
    v_cvt_pk_bf16_f32 v28, v28, v30
    ds_write_b32 v4, v28 offset:4352
    v_mov_b32 v5, 4160
    v_mov_b32 v7, 1
    s_waitcnt lgkmcnt(0)
    ds_write_b32 v5, v7
    s_branch L_service
L_mlp:
    s_lshl_b32 s10, s3, 3
    s_add_u32 s10, s10, s4
    s_mov_b32 s45, 0xffff0000
    s_mov_b32 s7, 1048576
    s_load_dword s42, s[40:41], 0
    s_mov_b32 s43, 0x05040100
    s_mov_b32 s44, 0x07060302
    s_mov_b32 s52, 0xff00ff00
    s_mov_b32 s53, 0xff00ff00
    s_waitcnt vmcnt(8)
    v_lshlrev_b32 v12, 16, v8
    v_and_b32 v13, s45, v8
    v_lshlrev_b32 v14, 16, v9
    v_and_b32 v15, s45, v9
    v_lshlrev_b32 v16, 16, v10
    v_and_b32 v17, s45, v10
    v_lshlrev_b32 v18, 16, v11
    v_and_b32 v19, s45, v11
    v_add_f32 v20, v12, v13
    v_add_f32 v21, v14, v15
    v_add_f32 v22, v16, v17
    v_add_f32 v23, v18, v19
    v_add_f32 v20, v20, v21
    v_add_f32 v22, v22, v23
    v_add_f32 v20, v20, v22
    s_nop 1
    v_add_f32_dpp v20, v20, v20 row_ror:8 row_mask:0xf bank_mask:0xf
    s_nop 1
    v_add_f32_dpp v20, v20, v20 row_ror:4 row_mask:0xf bank_mask:0xf
    s_nop 1
    v_add_f32_dpp v20, v20, v20 row_ror:2 row_mask:0xf bank_mask:0xf
    s_nop 1
    v_add_f32_dpp v20, v20, v20 row_ror:1 row_mask:0xf bank_mask:0xf
    v_mov_b32 v21, v20
    s_nop 1
    v_permlane16_swap_b32 v20, v21
    v_add_f32 v20, v20, v21
    v_mov_b32 v21, v20
    s_nop 1
    v_permlane32_swap_b32 v20, v21
    v_add_f32 v20, v20, v21
    v_mul_f32 v20, 0x3b000000, v20
    v_sub_f32 v22, v12, v20
    v_mul_f32 v23, v22, v22
    v_sub_f32 v22, v13, v20
    v_fmac_f32 v23, v22, v22
    v_sub_f32 v22, v14, v20
    v_fmac_f32 v23, v22, v22
    v_sub_f32 v22, v15, v20
    v_fmac_f32 v23, v22, v22
    v_sub_f32 v22, v16, v20
    v_fmac_f32 v23, v22, v22
    v_sub_f32 v22, v17, v20
    v_fmac_f32 v23, v22, v22
    v_sub_f32 v22, v18, v20
    v_fmac_f32 v23, v22, v22
    v_sub_f32 v22, v19, v20
    v_fmac_f32 v23, v22, v22
    s_nop 1
    v_add_f32_dpp v23, v23, v23 row_ror:8 row_mask:0xf bank_mask:0xf
    s_nop 1
    v_add_f32_dpp v23, v23, v23 row_ror:4 row_mask:0xf bank_mask:0xf
    s_nop 1
    v_add_f32_dpp v23, v23, v23 row_ror:2 row_mask:0xf bank_mask:0xf
    s_nop 1
    v_add_f32_dpp v23, v23, v23 row_ror:1 row_mask:0xf bank_mask:0xf
    v_mov_b32 v21, v23
    s_nop 1
    v_permlane16_swap_b32 v23, v21
    v_add_f32 v23, v23, v21
    v_mov_b32 v21, v23
    s_nop 1
    v_permlane32_swap_b32 v23, v21
    v_add_f32 v23, v23, v21
    v_mul_f32 v23, 0x3b000000, v23
    v_cvt_pk_bf16_f32 v20, v20, v20
    v_and_b32 v20, s45, v20
    v_cvt_pk_bf16_f32 v23, v23, v23
    v_and_b32 v23, s45, v23
    v_add_f32 v23, 0x3727c5ac, v23
    v_cvt_pk_bf16_f32 v23, v23, v23
    v_and_b32 v23, s45, v23
    v_sqrt_f32 v23, v23
    s_nop 0
    v_cvt_pk_bf16_f32 v23, v23, v23
    v_and_b32 v23, s45, v23
    v_rcp_f32 v24, v23
    v_sub_f32 v12, v12, v20
    v_sub_f32 v13, v13, v20
    v_cvt_pk_bf16_f32 v13, v12, v13
    v_lshlrev_b32 v12, 16, v13
    v_and_b32 v13, s45, v13
    v_mul_f32 v25, v12, v24
    v_mul_f32 v26, v13, v24
    v_fma_f32 v12, -v25, v23, v12
    v_fma_f32 v13, -v26, v23, v13
    v_fmac_f32 v25, v12, v24
    v_fmac_f32 v26, v13, v24
    v_cvt_pk_bf16_f32 v8, v25, v26
    v_sub_f32 v14, v14, v20
    v_sub_f32 v15, v15, v20
    v_cvt_pk_bf16_f32 v15, v14, v15
    v_lshlrev_b32 v14, 16, v15
    v_and_b32 v15, s45, v15
    v_mul_f32 v25, v14, v24
    v_mul_f32 v26, v15, v24
    v_fma_f32 v14, -v25, v23, v14
    v_fma_f32 v15, -v26, v23, v15
    v_fmac_f32 v25, v14, v24
    v_fmac_f32 v26, v15, v24
    v_cvt_pk_bf16_f32 v9, v25, v26
    v_sub_f32 v16, v16, v20
    v_sub_f32 v17, v17, v20
    v_cvt_pk_bf16_f32 v17, v16, v17
    v_lshlrev_b32 v16, 16, v17
    v_and_b32 v17, s45, v17
    v_mul_f32 v25, v16, v24
    v_mul_f32 v26, v17, v24
    v_fma_f32 v16, -v25, v23, v16
    v_fma_f32 v17, -v26, v23, v17
    v_fmac_f32 v25, v16, v24
    v_fmac_f32 v26, v17, v24
    v_cvt_pk_bf16_f32 v10, v25, v26
    v_sub_f32 v18, v18, v20
    v_sub_f32 v19, v19, v20
    v_cvt_pk_bf16_f32 v19, v18, v19
    v_lshlrev_b32 v18, 16, v19
    v_and_b32 v19, s45, v19
    v_mul_f32 v25, v18, v24
    v_mul_f32 v26, v19, v24
    v_fma_f32 v18, -v25, v23, v18
    v_fma_f32 v19, -v26, v23, v19
    v_fmac_f32 v25, v18, v24
    v_fmac_f32 v26, v19, v24
    v_cvt_pk_bf16_f32 v11, v25, v26
    v_lshlrev_b32 v12, 16, v8
    v_and_b32 v13, s45, v8
    v_lshlrev_b32 v14, 16, v9
    v_and_b32 v15, s45, v9
    v_lshlrev_b32 v16, 16, v10
    v_and_b32 v17, s45, v10
    v_lshlrev_b32 v18, 16, v11
    v_and_b32 v19, s45, v11
    v_add_f32 v20, v12, v13
    v_add_f32 v21, v14, v15
    v_add_f32 v22, v16, v17
    v_add_f32 v23, v18, v19
    v_add_f32 v20, v20, v21
    v_add_f32 v22, v22, v23
    v_add_f32 v20, v20, v22
    s_nop 1
    v_add_f32_dpp v20, v20, v20 row_ror:8 row_mask:0xf bank_mask:0xf
    s_nop 1
    v_add_f32_dpp v20, v20, v20 row_ror:4 row_mask:0xf bank_mask:0xf
    s_nop 1
    v_add_f32_dpp v20, v20, v20 row_ror:2 row_mask:0xf bank_mask:0xf
    s_nop 1
    v_add_f32_dpp v20, v20, v20 row_ror:1 row_mask:0xf bank_mask:0xf
    v_mov_b32 v21, v20
    s_nop 1
    v_permlane16_swap_b32 v20, v21
    v_add_f32 v20, v20, v21
    v_mov_b32 v21, v20
    s_nop 1
    v_permlane32_swap_b32 v20, v21
    v_add_f32 v20, v20, v21
    v_mul_f32 v20, 0x3b000000, v20
    v_sub_f32 v22, v12, v20
    v_mul_f32 v23, v22, v22
    v_sub_f32 v22, v13, v20
    v_fmac_f32 v23, v22, v22
    v_sub_f32 v22, v14, v20
    v_fmac_f32 v23, v22, v22
    v_sub_f32 v22, v15, v20
    v_fmac_f32 v23, v22, v22
    v_sub_f32 v22, v16, v20
    v_fmac_f32 v23, v22, v22
    v_sub_f32 v22, v17, v20
    v_fmac_f32 v23, v22, v22
    v_sub_f32 v22, v18, v20
    v_fmac_f32 v23, v22, v22
    v_sub_f32 v22, v19, v20
    v_fmac_f32 v23, v22, v22
    s_nop 1
    v_add_f32_dpp v23, v23, v23 row_ror:8 row_mask:0xf bank_mask:0xf
    s_nop 1
    v_add_f32_dpp v23, v23, v23 row_ror:4 row_mask:0xf bank_mask:0xf
    s_nop 1
    v_add_f32_dpp v23, v23, v23 row_ror:2 row_mask:0xf bank_mask:0xf
    s_nop 1
    v_add_f32_dpp v23, v23, v23 row_ror:1 row_mask:0xf bank_mask:0xf
    v_mov_b32 v21, v23
    s_nop 1
    v_permlane16_swap_b32 v23, v21
    v_add_f32 v23, v23, v21
    v_mov_b32 v21, v23
    s_nop 1
    v_permlane32_swap_b32 v23, v21
    v_add_f32 v23, v23, v21
    v_mul_f32 v23, 0x3b000000, v23
    v_cvt_pk_bf16_f32 v20, v20, v20
    v_and_b32 v20, s45, v20
    v_cvt_pk_bf16_f32 v23, v23, v23
    v_and_b32 v23, s45, v23
    v_add_f32 v23, 0x3727c5ac, v23
    v_cvt_pk_bf16_f32 v23, v23, v23
    v_and_b32 v23, s45, v23
    v_sqrt_f32 v23, v23
    s_nop 0
    v_cvt_pk_bf16_f32 v23, v23, v23
    v_and_b32 v23, s45, v23
    v_rcp_f32 v24, v23
    v_sub_f32 v12, v12, v20
    v_sub_f32 v13, v13, v20
    v_cvt_pk_bf16_f32 v13, v12, v13
    v_lshlrev_b32 v12, 16, v13
    v_and_b32 v13, s45, v13
    v_mul_f32 v25, v12, v24
    v_mul_f32 v26, v13, v24
    v_fma_f32 v12, -v25, v23, v12
    v_fma_f32 v13, -v26, v23, v13
    v_fmac_f32 v25, v12, v24
    v_fmac_f32 v26, v13, v24
    v_cvt_pk_bf16_f32 v8, v25, v26
    v_sub_f32 v14, v14, v20
    v_sub_f32 v15, v15, v20
    v_cvt_pk_bf16_f32 v15, v14, v15
    v_lshlrev_b32 v14, 16, v15
    v_and_b32 v15, s45, v15
    v_mul_f32 v25, v14, v24
    v_mul_f32 v26, v15, v24
    v_fma_f32 v14, -v25, v23, v14
    v_fma_f32 v15, -v26, v23, v15
    v_fmac_f32 v25, v14, v24
    v_fmac_f32 v26, v15, v24
    v_cvt_pk_bf16_f32 v9, v25, v26
    v_sub_f32 v16, v16, v20
    v_sub_f32 v17, v17, v20
    v_cvt_pk_bf16_f32 v17, v16, v17
    v_lshlrev_b32 v16, 16, v17
    v_and_b32 v17, s45, v17
    v_mul_f32 v25, v16, v24
    v_mul_f32 v26, v17, v24
    v_fma_f32 v16, -v25, v23, v16
    v_fma_f32 v17, -v26, v23, v17
    v_fmac_f32 v25, v16, v24
    v_fmac_f32 v26, v17, v24
    v_cvt_pk_bf16_f32 v10, v25, v26
    v_sub_f32 v18, v18, v20
    v_sub_f32 v19, v19, v20
    v_cvt_pk_bf16_f32 v19, v18, v19
    v_lshlrev_b32 v18, 16, v19
    v_and_b32 v19, s45, v19
    v_mul_f32 v25, v18, v24
    v_mul_f32 v26, v19, v24
    v_fma_f32 v18, -v25, v23, v18
    v_fma_f32 v19, -v26, v23, v19
    v_fmac_f32 v25, v18, v24
    v_fmac_f32 v26, v19, v24
    v_cvt_pk_bf16_f32 v11, v25, v26
    ds_write_b128 v5, v[8:11] offset:5632
    s_lshl_b32 s8, s4, 7
    v_lshl_add_u32 v6, v6, 4, s8
    ds_read_b128 v[28:31], v6 offset:5632
    v_mov_b32 v20, 0
    v_mov_b32 v21, 0
    v_mov_b32 v22, 0
    v_mov_b32 v23, 0
    v_mov_b32 v24, 0
    v_mov_b32 v25, 0
    v_mov_b32 v26, 0
    v_mov_b32 v27, 0
    s_waitcnt lgkmcnt(0)
    s_add_u32 s6, s42, 0x9e3779b9
    s_and_b32 s6, s6, -16
    s_getreg_b32 s49, hwreg(HW_REG_XCC_ID, 0, 4)
    s_or_b32 s49, s49, s6
    s_waitcnt vmcnt(0)
    v_perm_b32 v36, v68, v64, s43
    v_perm_b32 v37, v68, v64, s44
    v_perm_b32 v38, v69, v65, s43
    v_perm_b32 v39, v69, v65, s44
    v_perm_b32 v40, v70, v66, s43
    v_perm_b32 v41, v70, v66, s44
    v_perm_b32 v42, v71, v67, s43
    v_perm_b32 v43, v71, v67, s44
    v_dot2c_f32_bf16 v20, v36, v28
    v_dot2c_f32_bf16 v21, v37, v28
    v_dot2c_f32_bf16 v22, v38, v28
    v_dot2c_f32_bf16 v23, v39, v28
    v_dot2c_f32_bf16 v24, v40, v28
    v_dot2c_f32_bf16 v25, v41, v28
    v_dot2c_f32_bf16 v26, v42, v28
    v_dot2c_f32_bf16 v27, v43, v28
    v_perm_b32 v44, v76, v72, s43
    v_perm_b32 v45, v76, v72, s44
    v_perm_b32 v46, v77, v73, s43
    v_perm_b32 v47, v77, v73, s44
    v_perm_b32 v48, v78, v74, s43
    v_perm_b32 v49, v78, v74, s44
    v_perm_b32 v50, v79, v75, s43
    v_perm_b32 v51, v79, v75, s44
    v_dot2c_f32_bf16 v20, v44, v29
    v_dot2c_f32_bf16 v21, v45, v29
    v_dot2c_f32_bf16 v22, v46, v29
    v_dot2c_f32_bf16 v23, v47, v29
    v_dot2c_f32_bf16 v24, v48, v29
    v_dot2c_f32_bf16 v25, v49, v29
    v_dot2c_f32_bf16 v26, v50, v29
    v_dot2c_f32_bf16 v27, v51, v29
    v_perm_b32 v36, v84, v80, s43
    v_perm_b32 v37, v84, v80, s44
    v_perm_b32 v38, v85, v81, s43
    v_perm_b32 v39, v85, v81, s44
    v_perm_b32 v40, v86, v82, s43
    v_perm_b32 v41, v86, v82, s44
    v_perm_b32 v42, v87, v83, s43
    v_perm_b32 v43, v87, v83, s44
    v_dot2c_f32_bf16 v20, v36, v30
    v_dot2c_f32_bf16 v21, v37, v30
    v_dot2c_f32_bf16 v22, v38, v30
    v_dot2c_f32_bf16 v23, v39, v30
    v_dot2c_f32_bf16 v24, v40, v30
    v_dot2c_f32_bf16 v25, v41, v30
    v_dot2c_f32_bf16 v26, v42, v30
    v_dot2c_f32_bf16 v27, v43, v30
    v_perm_b32 v44, v92, v88, s43
    v_perm_b32 v45, v92, v88, s44
    v_perm_b32 v46, v93, v89, s43
    v_perm_b32 v47, v93, v89, s44
    v_perm_b32 v48, v94, v90, s43
    v_perm_b32 v49, v94, v90, s44
    v_perm_b32 v50, v95, v91, s43
    v_perm_b32 v51, v95, v91, s44
    v_dot2c_f32_bf16 v20, v44, v31
    v_dot2c_f32_bf16 v21, v45, v31
    v_dot2c_f32_bf16 v22, v46, v31
    v_dot2c_f32_bf16 v23, v47, v31
    v_dot2c_f32_bf16 v24, v48, v31
    v_dot2c_f32_bf16 v25, v49, v31
    v_dot2c_f32_bf16 v26, v50, v31
    v_dot2c_f32_bf16 v27, v51, v31
    v_permlane32_swap_b32 v20, v24
    v_permlane32_swap_b32 v21, v25
    v_permlane32_swap_b32 v22, v26
    v_permlane32_swap_b32 v23, v27
    v_add_f32 v20, v20, v24
    v_add_f32 v21, v21, v25
    v_add_f32 v22, v22, v26
    v_add_f32 v23, v23, v27
    s_nop 0
    v_permlane16_swap_b32 v20, v22
    v_permlane16_swap_b32 v21, v23
    v_add_f32 v20, v20, v22
    v_add_f32 v21, v21, v23
    s_nop 0
    v_add_f32_dpp v20, v20, v20 row_ror:8 row_mask:0xf bank_mask:0xf
    v_add_f32_dpp v21, v21, v21 row_ror:8 row_mask:0xf bank_mask:0xf
    v_cndmask_b32 v20, v20, v21, s[52:53]
    s_lshl_b32 s8, s3, 3
    s_add_u32 s8, s8, s4
    s_lshl_b32 s8, s8, 9
    s_add_u32 s8, s8, 327680
    v_lshl_add_u32 v4, v1, 3, s8
    v_mov_b32 v26, v20
    v_mov_b32 v27, s49
    s_lshl_b32 s8, s3, 12
    s_add_u32 s8, s8, 327680
    v_lshl_add_u32 v6, v1, 3, s8
    global_store_dwordx2 v4, v[26:27], s[40:41]
    v_lshrrev_b32 v6, 3, v1
    s_lshl_b32 s8, s46, 13
    s_lshl_b32 s9, s4, 7
    s_add_u32 s8, s8, s9
    s_movk_i32 s9, 0x2000
    v_lshlrev_b32 v14, 10, v6
    v_lshl_add_u32 v14, v7, 4, v14
    v_add_u32 v104, s8, v14
    v_add_u32 v105, s9, v104
    v_add_u32 v106, s9, v105
    v_add_u32 v107, s9, v106
    v_add_u32 v108, s9, v107
    v_add_u32 v109, s9, v108
    v_mov_b32 v132, 0
    v_mov_b32 v133, 0
    v_mov_b32 v134, 0
    v_mov_b32 v135, 0
    global_load_dwordx4 v[112:115], v104, s[32:33] nt
    global_load_dwordx4 v[116:119], v105, s[32:33] nt
    global_load_dwordx4 v[120:123], v106, s[32:33] nt
    global_load_dwordx4 v[124:127], v107, s[32:33] nt
    global_load_dwordx4 v[128:131], v108, s[32:33] nt
    s_cmp_le_u32 s47, 5
    s_cbranch_scc1 L_no6
    global_load_dwordx4 v[132:135], v109, s[32:33] nt
L_no6:
    s_mov_b64 exec, s[50:51]
    global_load_ushort v60, v61, s[30:31]
    s_mov_b64 exec, -1
    s_lshl_b32 s8, s3, 12
    s_add_u32 s8, s8, 327680
    v_lshl_add_u32 v6, v1, 3, s8
    s_mov_b32 s48, 0
    v_mov_b32 v62, 4168
L_phw:
    ds_read_b32 v63, v62
    s_waitcnt lgkmcnt(0)
    v_cmp_gt_u32 vcc, 8, v63
    s_cbranch_vccz L_phw_ok
    s_sub_u32 s7, s7, 1
    s_cbranch_scc1 L_end
    s_sleep 4
    s_branch L_phw
L_phw_ok:
    s_mov_b32 s14, 3
L_ph:
    global_load_dwordx2 v[8:9], v6, s[40:41] offset:0 sc1
    global_load_dwordx2 v[10:11], v6, s[40:41] offset:512 sc1
    global_load_dwordx2 v[12:13], v6, s[40:41] offset:1024 sc1
    global_load_dwordx2 v[14:15], v6, s[40:41] offset:1536 sc1
    global_load_dwordx2 v[16:17], v6, s[40:41] offset:2048 sc1
    global_load_dwordx2 v[18:19], v6, s[40:41] offset:2560 sc1
    global_load_dwordx2 v[20:21], v6, s[40:41] offset:3072 sc1
    global_load_dwordx2 v[22:23], v6, s[40:41] offset:3584 sc1
    s_waitcnt vmcnt(0)
    v_xor_b32 v24, s49, v9
    v_bitop3_b32 v24, v24, v11, s49 bitop3:0xf6
    v_bitop3_b32 v24, v24, v13, s49 bitop3:0xf6
    v_bitop3_b32 v24, v24, v15, s49 bitop3:0xf6
    v_bitop3_b32 v24, v24, v17, s49 bitop3:0xf6
    v_bitop3_b32 v24, v24, v19, s49 bitop3:0xf6
    v_bitop3_b32 v24, v24, v21, s49 bitop3:0xf6
    v_bitop3_b32 v24, v24, v23, s49 bitop3:0xf6
    v_cmp_ne_u32 vcc, 0, v24
    s_cbranch_vccz L_ph_ok
    v_cmp_lt_u32 vcc, 15, v24
    s_cbranch_vccz L_ph_far
    s_cmp_lg_u32 s14, 0
    s_cbranch_scc1 L_ph_r
    global_store_dwordx2 v4, v[26:27], s[40:41] sc1
L_ph_r:
    s_sub_u32 s14, s14, 1
    s_sub_u32 s7, s7, 1
    s_cbranch_scc1 L_end
    s_sleep 1
    s_branch L_ph
L_ph_far:
    global_store_dwordx2 v4, v[26:27], s[40:41] sc1
    s_mov_b32 s48, 1
L_ph_ok:
    v_add_f32 v8, v8, v10
    v_add_f32 v12, v12, v14
    v_add_f32 v16, v16, v18
    v_add_f32 v20, v20, v22
    v_add_f32 v8, v8, v12
    v_add_f32 v16, v16, v20
    v_add_f32 v8, v8, v16
    v_cvt_pk_bf16_f32 v8, v8, v8
    v_and_b32 v8, s45, v8
    v_lshlrev_b32 v60, 16, v60
    v_add_f32 v8, v8, v60
    v_cvt_pk_bf16_f32 v8, v8, v8
    v_and_b32 v8, s45, v8
    v_mul_f32 v9, v8, v8
    v_mov_b32 v10, 0xc0135761
    v_fmamk_f32 v9, v9, 0xbdd2d3e8, v10
    v_mul_f32 v9, v9, v8
    v_exp_f32 v9, v9
    s_nop 0
    v_add_f32 v9, 1.0, v9
    v_rcp_f32 v9, v9
    s_nop 0
    v_mul_f32 v8, v8, v9
    v_cndmask_b32 v8, 0, v8, s[50:51]
    ds_swizzle_b32 v10, v8 offset:24
    ds_swizzle_b32 v11, v8 offset:56
    ds_swizzle_b32 v12, v8 offset:88
    ds_swizzle_b32 v13, v8 offset:120
    ds_swizzle_b32 v14, v8 offset:152
    ds_swizzle_b32 v15, v8 offset:184
    v_mov_b32 v20, 0
    v_mov_b32 v21, 0
    v_mov_b32 v22, 0
    v_mov_b32 v23, 0
    v_mov_b32 v24, 0
    v_mov_b32 v25, 0
    v_mov_b32 v26, 0
    v_mov_b32 v27, 0
    s_waitcnt lgkmcnt(0)
    v_cvt_pk_bf16_f32 v10, v10, v11
    v_cvt_pk_bf16_f32 v12, v12, v13
    v_cvt_pk_bf16_f32 v14, v14, v15
    v_perm_b32 v28, v116, v112, s43
    v_perm_b32 v29, v116, v112, s44
    v_perm_b32 v30, v117, v113, s43
    v_perm_b32 v31, v117, v113, s44
    v_perm_b32 v32, v118, v114, s43
    v_perm_b32 v33, v118, v114, s44
    v_perm_b32 v34, v119, v115, s43
    v_perm_b32 v35, v119, v115, s44
    v_dot2c_f32_bf16 v20, v28, v10
    v_dot2c_f32_bf16 v21, v29, v10
    v_dot2c_f32_bf16 v22, v30, v10
    v_dot2c_f32_bf16 v23, v31, v10
    v_dot2c_f32_bf16 v24, v32, v10
    v_dot2c_f32_bf16 v25, v33, v10
    v_dot2c_f32_bf16 v26, v34, v10
    v_dot2c_f32_bf16 v27, v35, v10
    v_perm_b32 v28, v124, v120, s43
    v_perm_b32 v29, v124, v120, s44
    v_perm_b32 v30, v125, v121, s43
    v_perm_b32 v31, v125, v121, s44
    v_perm_b32 v32, v126, v122, s43
    v_perm_b32 v33, v126, v122, s44
    v_perm_b32 v34, v127, v123, s43
    v_perm_b32 v35, v127, v123, s44
    v_dot2c_f32_bf16 v20, v28, v12
    v_dot2c_f32_bf16 v21, v29, v12
    v_dot2c_f32_bf16 v22, v30, v12
    v_dot2c_f32_bf16 v23, v31, v12
    v_dot2c_f32_bf16 v24, v32, v12
    v_dot2c_f32_bf16 v25, v33, v12
    v_dot2c_f32_bf16 v26, v34, v12
    v_dot2c_f32_bf16 v27, v35, v12
    v_perm_b32 v28, v132, v128, s43
    v_perm_b32 v29, v132, v128, s44
    v_perm_b32 v30, v133, v129, s43
    v_perm_b32 v31, v133, v129, s44
    v_perm_b32 v32, v134, v130, s43
    v_perm_b32 v33, v134, v130, s44
    v_perm_b32 v34, v135, v131, s43
    v_perm_b32 v35, v135, v131, s44
    v_dot2c_f32_bf16 v20, v28, v14
    v_dot2c_f32_bf16 v21, v29, v14
    v_dot2c_f32_bf16 v22, v30, v14
    v_dot2c_f32_bf16 v23, v31, v14
    v_dot2c_f32_bf16 v24, v32, v14
    v_dot2c_f32_bf16 v25, v33, v14
    v_dot2c_f32_bf16 v26, v34, v14
    v_dot2c_f32_bf16 v27, v35, v14
    v_permlane32_swap_b32 v20, v24
    v_permlane32_swap_b32 v21, v25
    v_permlane32_swap_b32 v22, v26
    v_permlane32_swap_b32 v23, v27
    v_add_f32 v20, v20, v24
    v_add_f32 v21, v21, v25
    v_add_f32 v22, v22, v26
    v_add_f32 v23, v23, v27
    s_nop 0
    v_permlane16_swap_b32 v20, v22
    v_permlane16_swap_b32 v21, v23
    v_add_f32 v20, v20, v22
    v_add_f32 v21, v21, v23
    s_nop 0
    v_add_f32_dpp v20, v20, v20 row_ror:8 row_mask:0xf bank_mask:0xf
    v_add_f32_dpp v21, v21, v21 row_ror:8 row_mask:0xf bank_mask:0xf
    v_cndmask_b32 v20, v20, v21, s[52:53]
    v_lshlrev_b32 v6, 6, v7
    v_and_or_b32 v6, v1, 56, v6
    s_lshl_b32 s8, s4, 5
    s_add_u32 s8, s8, s3
    s_lshl_b32 s8, s8, 9
    s_add_u32 s8, s8, 1179648
    v_add_u32 v100, s8, v6
    v_mov_b32 v102, v20
    v_mov_b32 v103, s6
    global_store_dwordx2 v100, v[102:103], s[40:41] sc1
    s_branch L_service
L_h23:
    s_and_b32 s3, s2, 7
    s_bfe_u32 s9, s2, 0x20003
    s_lshl2_add_u32 s3, s3, s9
    s_lshr_b32 s4, s2, 5
    v_and_b32 v1, 63, v0
    v_and_b32 v2, 15, v0
    v_lshrrev_b32 v3, 4, v1
    s_lshl_b32 s10, s3, 3
    s_add_u32 s10, s10, s4
    s_mov_b32 s45, 0xffff0000
    s_mov_b32 s7, 1048576
    v_mov_b32 v100, 0
    s_lshl_b32 s8, s3, 23
    s_add_u32 s8, s8, 0x700000
    s_lshl_b32 s9, s3, 17
    s_load_dword s42, s[40:41], 0
    s_and_b32 s12, s3, 7
    s_xor_b32 s12, s12, s4
    s_xor_b32 s13, s5, 3
    s_or_b32 s12, s12, s13
    s_cbranch_scc1 L_nt
    s_load_dword s88, s[20:21], s8
    s_load_dword s89, s[24:25], s9
    s_load_dword s90, s[34:35], 0
    s_load_dword s91, s[36:37], 0
    s_getpc_b64 s[12:13]
L_pc:
    s_sub_u32 s12, s12, L_pc-L_pb_done
    s_subb_u32 s13, s13, 0
    s_load_dword s92, s[12:13], 0
    s_load_dword s93, s[12:13], 128
    s_load_dword s94, s[12:13], 256
    s_load_dword s95, s[12:13], 384
    s_load_dword s92, s[12:13], 512
    s_load_dword s93, s[12:13], 640
    s_load_dword s94, s[12:13], 768
    s_load_dword s95, s[12:13], 896
    s_load_dword s92, s[12:13], 1024
L_nt:
    s_waitcnt lgkmcnt(0)
    s_add_u32 s6, s42, 0x9e3779b9
    s_and_b32 s6, s6, -16
    s_cmp_lg_u32 s5, 3
    s_cbranch_scc1 L_service
    s_cmp_eq_u32 s10, 138
    s_cselect_b32 s9, 0x2000, 0
    s_cbranch_scc1 L_race
    s_cmp_lg_u32 s10, 129
    s_cbranch_scc1 L_service
L_race:
    s_load_dwordx2 s[50:51], s[40:41], 32768 glc
    s_add_u32 s8, s9, 1835008
    s_mov_b32 s57, 6
L_pr:
    s_waitcnt lgkmcnt(0)
    s_load_dword s88, s[40:41], s8 glc
    s_sub_u32 s57, s57, 1
    s_cbranch_scc0 L_pr
    v_mov_b32 v8, s9
    v_mov_b32 v9, s6
    v_mov_b32 v10, s50
    v_mov_b32 v11, s51
    v_mov_b32 v12, 32768
    s_cmp_eq_u32 s51, s6
    s_waitcnt lgkmcnt(0)
    s_cbranch_scc1 L_service
    s_mov_b64 exec, 1
    global_atomic_cmpswap_x2 v12, v[8:11], s[40:41] sc1
    s_mov_b64 exec, -1
    s_nop 1
L_service:
    v_and_b32 v6, 7, v1
    v_lshrrev_b32 v5, 3, v1
    v_and_b32 v7, 2, v5
    v_xor_b32 v7, v7, v6
    v_lshlrev_b32 v5, 10, v5
    v_lshl_add_u32 v5, v7, 4, v5
    s_lshl_b32 s8, s3, 17
    s_lshl_b32 s9, s5, 15
    s_add_u32 s8, s8, s9
    s_lshl_b32 s9, s4, 7
    s_add_u32 s8, s8, s9
    v_add_u32 v8, s8, v5
    v_xor_b32 v9, 0x2040, v8
    v_add_u32 v10, 0x4000, v8
    v_add_u32 v11, 0x4000, v9
    s_lshl_b32 s8, s5, 12
    v_lshl_add_u32 v12, v1, 4, s8
    v_lshrrev_b32 v13, 2, v2
    v_lshl_add_u32 v13, v3, 3, v13
    v_lshlrev_b32 v13, 7, v13
    v_and_b32 v14, 3, v2
    v_lshl_add_u32 v13, v14, 3, v13
    v_bfe_u32 v14, v1, 3, 2
    v_xor_b32 v14, s5, v14
    v_lshl_add_u32 v13, v14, 5, v13
    v_lshlrev_b32 v14, 3, v6
    v_lshlrev_b32 v15, 3, v1
    s_lshl_b32 s8, s10, 10
    s_add_u32 s8, s8, 524288
    v_add_u32 v16, s8, v15
    v_mul_u32_u24 v61, 272, v6
    v_mov_b32 v60, 4172
    v_mov_b32 v17, 1
    v_and_b32 v63, 8, v1
    v_lshl_add_u32 v62, v63, 4, v61
    v_lshl_add_u32 v62, v3, 4, v62
    s_lshl_b32 s8, s4, 5
    s_add_u32 s8, s8, s3
    s_lshl_b32 s8, s8, 9
    s_lshl_b32 s9, s5, 7
    s_add_u32 s8, s8, s9
    s_add_u32 s8, s8, 1048576
    s_lshl2_add_u32 s8, s4, s5
    s_mul_i32 s8, s8, 16384
    s_lshl_b32 s9, s3, 7
    s_add_u32 s8, s8, s9
    s_add_u32 s8, s8, 1310720
    v_lshl_add_u32 v19, v2, 3, s8
    s_mov_b32 s54, 0
    s_mov_b32 s55, -1
    v_mov_b32 v21, s6
    v_mov_b32 v23, s6
    v_mov_b32 v25, s6
    v_mov_b32 v27, s6
    v_mov_b32 v84, 32768
    v_mov_b32 v30, 4164
L_cw1:
    ds_read_b32 v31, v30
    s_waitcnt lgkmcnt(0)
    v_cmp_gt_u32 vcc, 1, v31
    s_cbranch_vccz L_cw1_ok
    s_sub_u32 s7, s7, 1
    s_cbranch_scc1 L_end
    s_sleep 4
    s_branch L_cw1
L_cw1_ok:
    global_load_dwordx2 v[86:87], v84, s[40:41] sc1
    v_mov_b32 v30, 4164
L_cw:
    ds_read_b32 v31, v30
    s_waitcnt lgkmcnt(0)
    v_cmp_gt_u32 vcc, 8, v31
    s_cbranch_vccz L_cw_ok
    s_sub_u32 s7, s7, 1
    s_cbranch_scc1 L_end
    s_sleep 4
    s_branch L_cw
L_cw_ok:
    s_lshl_b32 s8, s5, 12
    s_add_u32 m0, s8, 8192
    s_nop 0
    global_load_lds_dwordx4 v8, s[24:25] nt
    s_add_u32 m0, s8, 9216
    s_nop 0
    global_load_lds_dwordx4 v9, s[24:25] nt
    s_add_u32 m0, s8, 10240
    s_nop 0
    global_load_lds_dwordx4 v10, s[24:25] nt
    s_add_u32 m0, s8, 11264
    s_nop 0
    global_load_lds_dwordx4 v11, s[24:25] nt
    s_waitcnt vmcnt(4)
    s_branch L_ch1
L_ch:
    global_load_dwordx2 v[86:87], v84, s[40:41] sc1
    s_waitcnt vmcnt(0)
L_ch1:
    v_cmp_ne_u32 vcc, s6, v87
    s_cbranch_vccz L_ch_ok
    s_sub_u32 s7, s7, 1
    s_cbranch_scc1 L_end
    s_sleep 1
    s_branch L_ch
L_ch_ok:
    v_and_b32 v86, 0x2000, v86
    v_add_u32 v19, v19, v86
    s_cmp_lg_u32 s5, 0
    s_cbranch_scc1 L_h123
    ds_read_b64 v[28:29], v14 offset:4096
    s_waitcnt lgkmcnt(0)
    v_max_f32_dpp v20, v28, v28 row_ror:4 row_mask:0xf bank_mask:0xf
    s_nop 1
    v_max_f32_dpp v20, v20, v20 row_ror:2 row_mask:0xf bank_mask:0xf
    s_nop 1
    v_max_f32_dpp v20, v20, v20 row_ror:1 row_mask:0xf bank_mask:0xf
    v_sub_f32 v28, v28, v20
    v_exp_f32 v28, v28
    s_nop 0
    v_mul_f32 v22, v28, v29
    s_nop 1
    v_add_f32_dpp v22, v22, v22 row_ror:4 row_mask:0xf bank_mask:0xf
    s_nop 1
    v_add_f32_dpp v22, v22, v22 row_ror:2 row_mask:0xf bank_mask:0xf
    s_nop 1
    v_add_f32_dpp v22, v22, v22 row_ror:1 row_mask:0xf bank_mask:0xf
    s_mul_i32 s8, s4, 272
    s_add_u32 s8, s8, 24576
    v_lshl_add_u32 v18, v1, 2, s8
    s_mov_b64 exec, 1
    ds_write2_b32 v18, v20, v22 offset0:64 offset1:65
    s_cmp_lg_u32 s48, 0
    s_cbranch_scc1 L_mlfar
    global_store_dwordx4 v16, v[20:23], s[40:41] offset:512
    s_branch L_mld
L_mlfar:
    global_store_dwordx4 v16, v[20:23], s[40:41] offset:512 sc1
L_mld:
    s_mov_b64 exec, -1
    s_barrier
    ds_read2st64_b64 v[32:35], v15 offset0:0 offset1:1
    ds_read2st64_b64 v[36:39], v15 offset0:2 offset1:3
    ds_read2st64_b64 v[40:43], v15 offset0:4 offset1:5
    ds_read2st64_b64 v[44:47], v15 offset0:6 offset1:7
    s_waitcnt lgkmcnt(3)
    v_mul_f32_dpp v24, v28, v32 row_newbcast:0 row_mask:0xf bank_mask:0xf
    v_mul_f32_dpp v30, v28, v33 row_newbcast:0 row_mask:0xf bank_mask:0xf
    v_mul_f32_dpp v48, v28, v34 row_newbcast:1 row_mask:0xf bank_mask:0xf
    v_mul_f32_dpp v49, v28, v35 row_newbcast:1 row_mask:0xf bank_mask:0xf
    s_waitcnt lgkmcnt(2)
    v_fmac_f32_dpp v24, v28, v36 row_newbcast:2 row_mask:0xf bank_mask:0xf
    v_fmac_f32_dpp v30, v28, v37 row_newbcast:2 row_mask:0xf bank_mask:0xf
    v_fmac_f32_dpp v48, v28, v38 row_newbcast:3 row_mask:0xf bank_mask:0xf
    v_fmac_f32_dpp v49, v28, v39 row_newbcast:3 row_mask:0xf bank_mask:0xf
    s_waitcnt lgkmcnt(1)
    v_fmac_f32_dpp v24, v28, v40 row_newbcast:4 row_mask:0xf bank_mask:0xf
    v_fmac_f32_dpp v30, v28, v41 row_newbcast:4 row_mask:0xf bank_mask:0xf
    v_fmac_f32_dpp v48, v28, v42 row_newbcast:5 row_mask:0xf bank_mask:0xf
    v_fmac_f32_dpp v49, v28, v43 row_newbcast:5 row_mask:0xf bank_mask:0xf
    s_waitcnt lgkmcnt(0)
    v_fmac_f32_dpp v24, v28, v44 row_newbcast:6 row_mask:0xf bank_mask:0xf
    v_fmac_f32_dpp v30, v28, v45 row_newbcast:6 row_mask:0xf bank_mask:0xf
    v_fmac_f32_dpp v48, v28, v46 row_newbcast:7 row_mask:0xf bank_mask:0xf
    v_fmac_f32_dpp v49, v28, v47 row_newbcast:7 row_mask:0xf bank_mask:0xf
    v_add_f32 v24, v24, v48
    v_add_f32 v30, v30, v49
    v_cvt_pk_bf16_f32 v24, v24, v30
    s_cbranch_scc1 L_far
    global_store_dwordx2 v16, v[24:25], s[40:41]
L_pubd:
    s_barrier
    ds_write_b32 v18, v24
    s_waitcnt lgkmcnt(0)
    s_waitcnt vmcnt(2)
    s_branch L_wo
L_far:
    global_store_dwordx2 v16, v[24:25], s[40:41] sc1
    s_nop 1
    s_branch L_pubd
L_h123:
    s_cmp_lg_u32 s5, 1
    s_barrier
    s_barrier
    s_waitcnt vmcnt(0)
L_wo:
    s_mov_b64 exec, 1
    ds_add_u32 v60, v17
    s_mov_b64 exec, -1
L_cw3:
    ds_read_b32 v31, v60
    s_waitcnt lgkmcnt(0)
    v_cmp_gt_u32 vcc, 4, v31
    s_cbranch_vccz L_cw3_ok
    s_sub_u32 s7, s7, 1
    s_cbranch_scc1 L_end
    s_nop 0
    s_branch L_cw3
L_cw3_ok:
    ds_read_b64_tr_b16 v[64:65], v13 offset:8192
    ds_read_b64_tr_b16 v[66:67], v13 offset:8704
    ds_read_b64_tr_b16 v[68:69], v13 offset:12288
    ds_read_b64_tr_b16 v[70:71], v13 offset:12800
    ds_read_b64_tr_b16 v[72:73], v13 offset:16384
    ds_read_b64_tr_b16 v[74:75], v13 offset:16896
    ds_read_b64_tr_b16 v[76:77], v13 offset:20480
    ds_read_b64_tr_b16 v[78:79], v13 offset:20992
    s_barrier
    ds_read_b64 v[28:29], v61 offset:24832
    ds_read_b128 v[32:35], v62 offset:24576
    ds_read_b128 v[40:43], v62 offset:24640
    s_waitcnt lgkmcnt(1)
    v_max_f32_dpp v48, v28, v28 row_ror:4 row_mask:0xf bank_mask:0xf
    v_mfma_f32_16x16x32_bf16 v[52:55], v[32:35], v[64:67], 0
    v_mfma_f32_16x16x32_bf16 v[56:59], v[32:35], v[72:75], 0
    s_waitcnt lgkmcnt(0)
    v_max_f32_dpp v48, v48, v48 row_ror:2 row_mask:0xf bank_mask:0xf
    v_mfma_f32_16x16x32_bf16 v[52:55], v[40:43], v[68:71], v[52:55]
    v_mfma_f32_16x16x32_bf16 v[56:59], v[40:43], v[76:79], v[56:59]
    v_max_f32_dpp v48, v48, v48 row_ror:1 row_mask:0xf bank_mask:0xf
    v_sub_f32 v28, v28, v48
    v_exp_f32 v28, v28
    s_nop 0
    v_mul_f32 v30, v28, v29
    s_nop 1
    v_add_f32_dpp v30, v30, v30 row_ror:4 row_mask:0xf bank_mask:0xf
    s_nop 1
    v_add_f32_dpp v30, v30, v30 row_ror:2 row_mask:0xf bank_mask:0xf
    s_nop 1
    v_add_f32_dpp v30, v30, v30 row_ror:1 row_mask:0xf bank_mask:0xf
    v_mov_b32_dpp v28, v28 row_ror:4 row_mask:0xa bank_mask:0xf
    v_rcp_f32 v30, v30
    v_cndmask_b32 v52, v52, v56, s[54:55]
    v_cndmask_b32 v53, v53, v57, s[54:55]
    v_cndmask_b32 v54, v54, v58, s[54:55]
    v_cndmask_b32 v55, v55, v59, s[54:55]
    v_mul_f32_dpp v26, v28, v52 row_newbcast:0 row_mask:0xf bank_mask:0xf
    v_mul_f32_dpp v48, v28, v53 row_newbcast:1 row_mask:0xf bank_mask:0xf
    s_nop 0
    v_fmac_f32_dpp v26, v28, v54 row_newbcast:2 row_mask:0xf bank_mask:0xf
    v_fmac_f32_dpp v48, v28, v55 row_newbcast:3 row_mask:0xf bank_mask:0xf
    v_add_f32 v26, v26, v48
    v_mul_f32 v26, v26, v30
    v_mov_b32 v48, v26
    s_nop 1
    v_permlane16_swap_b32 v26, v48
    v_add_f32 v26, v26, v48
    v_mov_b32 v48, v26
    s_nop 1
    v_permlane32_swap_b32 v26, v48
    v_add_f32 v26, v26, v48
    s_mov_b64 exec, 0xffff
    global_store_dwordx2 v19, v[26:27], s[40:41] sc1
    s_barrier
L_end:
    s_endpgm
.section .rodata,"a"
.p2align 6
.amdhsa_kernel recurrent_scan__sliding_block_cached__mixer_channel_mlp__decode_kernel
  .amdhsa_next_free_vgpr 168
  .amdhsa_next_free_sgpr 96
  .amdhsa_accum_offset 168
  .amdhsa_group_segment_fixed_size 0
  .amdhsa_kernarg_size 104
  .amdhsa_user_sgpr_count 2
  .amdhsa_user_sgpr_kernarg_segment_ptr 1
  .amdhsa_system_sgpr_workgroup_id_x 1
  .amdhsa_float_denorm_mode_32 3
.end_amdhsa_kernel
```
